```python
import torch

def _softmax(x, axis=-1):
    return torch.softmax(x, dim=axis)
def _gelu(x):
    return torch.nn.functional.gelu(x, approximate="tanh")
def _silu(x):
    return torch.nn.functional.silu(x)
def _sigmoid(x):
    return torch.sigmoid(x)
def _layernorm(x, axis=-1, eps=1e-5):
    m = x.mean(dim=axis, keepdim=True)
    v = x.var(dim=axis, keepdim=True, unbiased=False)
    return (x - m) / torch.sqrt(v + eps)
def _scatter_add(tgt, idx, src, axis=0):
    return tgt.clone().index_add_(axis, idx, src)
def _segment_sum(src, seg, n):
    out = torch.zeros((n,) + src.shape[1:], dtype=src.dtype)
    return out.index_add_(0, seg, src)
def _pad(x, pw):
    flat = tuple(v for pair in reversed(pw) for v in pair)
    return torch.nn.functional.pad(x, flat)

kernel_name = 'concat_heads__grouped_kv_mqa__linear_attn_block__prompt'

def setup_inputs():

    _w = (lambda a: (lambda t: t.to(torch.bfloat16) if t.is_floating_point() else t)(torch.as_tensor(a)))
    def _A_setup():
        B, S, D, H = 1, 2048, 640, 32
        Dh = D // H
        return {
            "x": _w((lambda *s: torch.randn(*s, dtype=torch.bfloat16) * 0.05)(B, S, D)),
            "wq": _w((lambda *s: torch.randn(*s, dtype=torch.bfloat16) * 0.8)(D, H * Dh)),
            "wk": _w((lambda *s: torch.randn(*s, dtype=torch.bfloat16) * 0.8)(D, Dh)),
            "wv": _w((lambda *s: torch.randn(*s, dtype=torch.bfloat16) * 0.05)(D, Dh)),
            "wo": _w((lambda *s: torch.randn(*s, dtype=torch.bfloat16) * 0.05)(H * Dh, D)),
        }
    _A_in = _A_setup()

    def _B_setup():
        B, S, D = 1, 2048, 640
        return {
            "x": _w((lambda *s: torch.randn(*s, dtype=torch.bfloat16) * 0.05)(B, S, D)),
            "wqkv": _w((lambda *s: torch.randn(*s, dtype=torch.bfloat16) * 0.4)(D, 3 * D)),
            "wo": _w((lambda *s: torch.randn(*s, dtype=torch.bfloat16) * 0.05)(D, D)),
        }
    _B_in = _B_setup()

    return {
        "A_x": _A_in["x"],
        "A_wq": _A_in["wq"],
        "A_wk": _A_in["wk"],
        "A_wv": _A_in["wv"],
        "A_wo": _A_in["wo"],
        "B_x": _B_in["x"],
        "B_wqkv": _B_in["wqkv"],
        "B_wo": _B_in["wo"],
    }

def reference(A_x, A_wq, A_wk, A_wv, A_wo, B_x, B_wqkv, B_wo):
    def _A_ref(x, wq, wk, wv, wo):
        B, S, D = x.shape
        H = 32
        Dh = D // H
        q = (lambda x, *d: x.permute(*d))((x @ wq).reshape(B, S, H, Dh), 0, 2, 1, 3)
        k = x @ wk
        v = x @ wv
        scores = torch.einsum("bhqd,bkd->bhqk", q, k) * (Dh ** -0.5)
        p = _softmax(scores, axis=-1)
        o = torch.einsum("bhqk,bkd->bhqd", p, v)
        return (lambda x, *d: x.permute(*d))(o, 0, 2, 1, 3).reshape(B, S, H * Dh) @ wo

    def _B_ref(x, wqkv, wo):
        B, S, D = x.shape
        H = 32; Dh = D // H
        qkv = (lambda x, *d: x.permute(*d))((x @ wqkv).reshape(B, S, 3, H, Dh), 2, 0, 3, 1, 4)
        q, k, v = qkv[0], qkv[1], qkv[2]
        phi = lambda t: torch.where(t > 0, t + 1, torch.exp(t)) + 1e-6
        pq, pk = phi(q), phi(k)
        kv = torch.einsum("bhsd,bhse->bhde", pk, v)
        z = torch.einsum("bhsd->bhd", pk)
        num = torch.einsum("bhqd,bhde->bhqe", pq, kv)
        den = torch.einsum("bhqd,bhd->bhq", pq, z)[..., None] + 1e-6
        o = num / den
        return (lambda x, *d: x.permute(*d))(o, 0, 2, 1, 3).reshape(B, S, D) @ wo

    a = _A_ref(A_x, A_wq, A_wk, A_wv, A_wo)
    b = _B_ref(B_x, B_wqkv, B_wo)
    return torch.concatenate([a, b], axis=-1)
```

```asm
; @launch grid=(256,1,1) block=(640,1,1) lds=163840
.amdgcn_target "amdgcn-amd-amdhsa--gfx950"
.text
.globl concat_heads__grouped_kv_mqa__linear_attn_block__prompt_kernel
.p2align 8
.type concat_heads__grouped_kv_mqa__linear_attn_block__prompt_kernel,@function
concat_heads__grouped_kv_mqa__linear_attn_block__prompt_kernel:
    s_load_dwordx16 s[16:31], s[0:1], 0
    s_load_dwordx4 s[32:35], s[0:1], 64
    s_load_dwordx2 s[36:37], s[0:1], 80
    s_getpc_b64 s[44:45]
L_pc:
    s_mov_b32 s46, L_codeend-L_pc
    s_mov_b32 s47, 0x20000
    v_lshlrev_b32 v4, 9, v0
    s_lshl_b32 s8, s2, 4
    s_and_b32 s8, s8, 384
    buffer_load_dword v164, v4, s[44:47], s8 offen
    s_cmp_ge_u32 s2, 256
    s_cbranch_scc1 L_end
    v_lshrrev_b32 v1, 6, v0
    v_and_b32 v0, 63, v0
    v_readfirstlane_b32 s3, v1
    s_and_b32 s6, s2, 7
    s_lshr_b32 s7, s2, 3
    s_lshr_b32 s4, s6, 1
    s_lshl_b32 s4, s4, 3
    s_lshr_b32 s8, s7, 2
    s_add_u32 s4, s4, s8
    s_and_b32 s5, s6, 1
    s_lshl_b32 s5, s5, 2
    s_and_b32 s8, s7, 3
    s_add_u32 s5, s5, s8
    s_cmp_lt_u32 s3, 8
    s_cbranch_scc1 C_start
    s_setprio 2
    s_sub_u32 s10, s3, 8
    s_mul_i32 s13, s4, 81920
    v_lshlrev_b32 v18, 4, v0
    s_cmp_eq_u32 s10, 1
    s_cbranch_scc1 L_mw
    v_lshrrev_b32 v20, 4, v0
    v_xor_b32 v21, v20, v0
    v_and_b32 v21, 15, v21
    v_lshlrev_b32 v21, 4, v21
    v_mul_u32_u24 v20, 1280, v20
    v_xor_b32 v28, 0, v21
    v_add_u32 v28, v28, v20
    v_add_u32 v20, 5120, v20
    v_xor_b32 v29, 64, v21
    v_add_u32 v29, v29, v20
    v_add_u32 v20, 5120, v20
    v_xor_b32 v30, 128, v21
    v_add_u32 v30, v30, v20
    v_add_u32 v20, 5120, v20
    v_xor_b32 v31, 192, v21
    v_add_u32 v31, v31, v20
    s_mov_b32 m0, 116736
    s_lshr_b32 s14, s5, 1
    s_mul_i32 s14, s14, 20480
    s_add_u32 s14, s14, s13
    s_mov_b32 s15, 0
    s_waitcnt lgkmcnt(0)
    s_mov_b32 s44, s16
    s_mov_b32 s45, s17
    s_mov_b32 s46, 2621440
    s_mov_b32 s47, 0x20000
L_mx:
    buffer_load_dwordx4 v28, s[44:47], s14 offen  lds
    s_add_u32 m0, m0, 1024
    s_nop 0
    buffer_load_dwordx4 v29, s[44:47], s14 offen  lds
    s_add_u32 m0, m0, 1024
    s_nop 0
    buffer_load_dwordx4 v30, s[44:47], s14 offen  lds
    s_add_u32 m0, m0, 1024
    s_nop 0
    buffer_load_dwordx4 v31, s[44:47], s14 offen  lds
    s_add_u32 m0, m0, 1024
    s_add_u32 s14, s14, 256
    s_add_u32 s15, s15, 1
    s_cmp_lt_u32 s15, 5
    s_cbranch_scc1 L_mx
    s_branch L_md
L_mw:
    s_mov_b32 m0, 137216
    s_mov_b32 s14, 0
    s_waitcnt lgkmcnt(0)
    s_bitcmp1_b32 s5, 0
    s_cselect_b32 s52, s22, s20
    s_cselect_b32 s53, s23, s21
    s_mov_b32 s54, 25600
    s_mov_b32 s55, 0x20000
L_mwl:
    buffer_load_dwordx4 v18, s[52:55], s14 offen offset:0 lds
    buffer_load_dwordx4 v18, s[52:55], s14 offen offset:1024 lds
    buffer_load_dwordx4 v18, s[52:55], s14 offen offset:2048 lds
    buffer_load_dwordx4 v18, s[52:55], s14 offen offset:3072 lds
    s_add_u32 m0, m0, 4096
    s_add_u32 s14, s14, 4096
    s_cmp_lt_u32 s14, 24576
    s_cbranch_scc1 L_mwl
    buffer_load_dwordx4 v18, s[52:55], s14 offen lds
    s_mov_b32 s44, s16
    s_mov_b32 s45, s17
    s_mov_b32 s46, 2621440
    s_mov_b32 s47, 0x20000
    s_branch L_md
C_start:
    s_cmp_lg_u32 s3, 4
    s_cbranch_scc1 C_pre
    s_cmp_ge_u32 s2, 8
    s_cbranch_scc1 C_pre
    s_memrealtime s[8:9]
    s_waitcnt lgkmcnt(0)
    s_or_b32 s8, s8, 1
    s_mov_b32 s44, s34
    s_mov_b32 s45, s35
    s_mov_b32 s46, 256
    s_mov_b32 s47, 0x20000
    v_mov_b32 v8, s8
    v_mov_b32 v9, 0
    v_mov_b32 v10, 0
    s_mov_b64 exec, 1
    buffer_atomic_cmpswap v[8:9], v10, s[44:47], 0 offen sc1
    s_mov_b64 exec, -1
C_pre:
    v_and_b32 v1, 31, v0
    v_lshrrev_b32 v2, 5, v0
    v_lshrrev_b32 v3, 2, v1
    v_add_u32 v3, 1, v3
    v_and_b32 v3, 2, v3
    v_mul_u32_u24 v3, 6, v3
    v_xor_b32 v3, v1, v3
    v_lshlrev_b32 v145, 3, v0
    v_lshlrev_b32 v146, 4, v0
    s_and_b32 s38, s3, 1
    s_lshr_b32 s39, s3, 1
    s_mov_b32 s76, 0
    s_mov_b32 s77, 128
    s_cmp_eq_u32 s3, 1
    s_cselect_b32 s76, 32, s76
    s_cselect_b32 s77, 64, s77
    s_cmp_eq_u32 s3, 2
    s_cselect_b32 s76, 96, s76
    s_cselect_b32 s77, 96, s77
    s_sub_u32 s78, s3, 3
    s_lshl_b32 s78, s78, 2
    s_lshr_b32 s78, 0x20431, s78
    s_and_b32 s78, s78, 15
    s_lshl_b32 s8, s78, 6
    s_add_u32 s8, s8, 18432
    s_add_u32 s9, s76, 8192
    s_sub_u32 s64, s77, s76
    s_cmp_lt_u32 s3, 3
    s_cselect_b32 s60, s9, s8
    s_cselect_b32 s64, s64, 32
    s_mov_b32 s61, 320
    s_cselect_b32 s61, 160, s61
    v_bfe_u32 v12, v0, 2, 2
    v_lshl_add_u32 v13, v2, 3, v12
    v_mul_u32_u24 v13, s61, v13
    v_bfe_u32 v15, v0, 4, 1
    v_mul_u32_u24 v14, s64, v15
    v_and_b32 v18, 3, v0
    v_lshlrev_b32 v18, 3, v18
    v_add3_u32 v13, v13, v14, v18
    v_add_u32 v140, s60, v13
    v_bfe_u32 v14, v0, 1, 3
    v_xor_b32 v14, v14, v2
    v_lshlrev_b32 v14, 4, v14
    v_lshl_or_b32 v141, v1, 7, v14
    v_xor_b32 v142, 32, v141
    v_xor_b32 v143, 64, v141
    v_xor_b32 v144, 96, v141
    s_mul_i32 s80, s4, 163840
    s_mul_i32 s8, s5, 160
    s_add_u32 s80, s80, s8
    s_cmp_ge_u32 s3, 4
    s_cbranch_scc1 PC_tz
    s_lshl_b32 s9, s39, 6
    s_add_u32 s80, s80, s9
    s_mul_i32 s10, s38, 81920
    s_add_u32 s80, s80, s10
    s_mul_i32 s8, s38, 5120
    s_add_u32 s8, s8, 102400
    s_lshl_b32 s9, s39, 10
    v_add_u32 v157, s9, v146
    s_lshl_b32 s9, s39, 8
    s_add_u32 s9, s9, 2560
    v_mul_u32_u24 v158, 3200, v2
    v_lshl_add_u32 v158, v1, 3, v158
    v_add_u32 v158, s9, v158
    v_add_u32 v159, s8, v146
    v_add_u32 v160, s8, v145
    s_branch PC_td
PC_tz:
    s_sub_u32 s8, s3, 4
    s_mul_i32 s10, s8, 40960
    s_add_u32 s80, s80, s10
    s_lshl_b32 s9, s38, 4
    s_lshr_b32 s8, s8, 1
    s_mul_i32 s8, s8, 5120
    s_add_u32 s8, s8, 102400
    v_lshrrev_b32 v12, 4, v0
    v_and_b32 v14, 15, v0
    v_mul_u32_u24 v157, 3200, v2
    v_lshl_add_u32 v157, v1, 4, v157
    v_add_u32 v157, 2048, v157
    v_mul_u32_u24 v158, 3200, v12
    v_lshl_add_u32 v158, v14, 3, v158
    v_add_u32 v158, 3072, v158
    v_add_u32 v14, s9, v14
    v_lshl_add_u32 v16, v12, 5, v14
    v_lshlrev_b32 v160, 3, v16
    v_add_u32 v160, s8, v160
    v_lshlrev_b32 v159, 4, v16
    v_add_u32 v159, s8, v159
PC_td:
    v_mov_b32 v161, 0
    v_add_u32 v136, 116736, v146
    v_lshlrev_b32 v137, 3, v1
    v_add_u32 v137, 117760, v137
    v_mul_u32_u24 v138, 320, v2
    v_lshl_add_u32 v138, v1, 4, v138
    v_add_u32 v138, 118016, v138
    v_add_u32 v139, 640, v138
    v_mov_b32 v155, v3
    s_mov_b32 exec_lo, 0x0ff00000
    s_mov_b32 exec_hi, 0
    v_mov_b32 v138, 119360
    v_mov_b32 v139, 119488
    s_mov_b32 exec_lo, 0xf0000000
    v_mov_b32 v138, 119488
    v_mov_b32 v139, 119360
    s_mov_b32 exec_lo, 0
    s_mov_b32 exec_hi, 0x0ff00000
    v_mov_b32 v138, 119424
    v_mov_b32 v139, 119296
    s_mov_b32 exec_hi, 0xf0000000
    v_mov_b32 v138, 119296
    v_mov_b32 v139, 119424
    s_mov_b32 exec_lo, 0xeef00000
    s_mov_b32 exec_hi, 0xeef00000
    v_add_u32 v138, 16, v138
    v_add_u32 v139, 16, v139
    s_mov_b32 exec_lo, 0xfff00000
    s_mov_b32 exec_hi, 0xfff00000
    v_mov_b32 v155, 20
    s_mov_b32 exec_lo, 0
    s_mov_b32 exec_hi, -1
    v_mov_b32 v137, 119296
    s_mov_b64 exec, -1
    s_mul_i32 s8, s39, 840
    s_add_u32 s8, s8, 112640
    v_mul_u32_u24 v155, 40, v155
    v_add_u32 v155, s8, v155
    v_lshl_add_u32 v156, v2, 4, v155
    s_lshl_b32 s10, s4, 3
    s_add_u32 s10, s10, s5
    s_lshl_b32 s10, s10, 1
    s_add_u32 s10, s10, s38
    s_mul_i32 s10, s10, 5120
    s_lshl_b32 s81, s39, 10
    s_add_u32 s81, s81, s10
    s_lshl_b32 s82, s39, 8
    s_add_u32 s82, s82, s10
    s_add_u32 s82, s82, 4096
    s_mul_i32 s8, s38, 5120
    s_add_u32 s8, s8, 77824
    s_lshl_b32 s9, s39, 10
    s_add_u32 s9, s9, s8
    v_add_u32 v154, s9, v146
    s_lshl_b32 s9, s39, 8
    s_add_u32 s9, s9, s8
    s_add_u32 s9, s9, 4096
    v_lshlrev_b32 v153, 3, v1
    v_add_u32 v153, s9, v153
    s_lshr_b32 s8, s76, 3
    s_add_u32 s8, s8, 0
    v_add_u32 v12, s8, v2
    v_mul_u32_u24 v13, 52, v12
    v_lshrrev_b32 v13, 8, v13
    v_mul_u32_u24 v14, 5, v13
    v_sub_u32 v14, v12, v14
    v_lshlrev_b32 v162, 10, v13
    v_lshl_add_u32 v162, v1, 4, v162
    v_lshrrev_b32 v15, 1, v14
    v_lshl_add_u32 v162, v15, 9, v162
    v_and_b32 v15, 1, v14
    v_lshl_add_u32 v162, v15, 3, v162
    v_cmp_eq_u32 vcc, 4, v14
    s_mov_b64 exec, vcc
    v_lshlrev_b32 v162, 8, v13
    v_lshl_add_u32 v162, v1, 3, v162
    v_add_u32 v162, 4096, v162
    s_mov_b64 exec, -1
    v_add_u32 v162, 77824, v162
    s_lshr_b32 s8, s76, 3
    s_add_u32 s8, s8, 2
    v_add_u32 v12, s8, v2
    v_mul_u32_u24 v13, 52, v12
    v_lshrrev_b32 v13, 8, v13
    v_mul_u32_u24 v14, 5, v13
    v_sub_u32 v14, v12, v14
    v_lshlrev_b32 v163, 10, v13
    v_lshl_add_u32 v163, v1, 4, v163
    v_lshrrev_b32 v15, 1, v14
    v_lshl_add_u32 v163, v15, 9, v163
    v_and_b32 v15, 1, v14
    v_lshl_add_u32 v163, v15, 3, v163
    v_cmp_eq_u32 vcc, 4, v14
    s_mov_b64 exec, vcc
    v_lshlrev_b32 v163, 8, v13
    v_lshl_add_u32 v163, v1, 3, v163
    v_add_u32 v163, 4096, v163
    s_mov_b64 exec, -1
    v_add_u32 v163, 77824, v163
    s_lshr_b32 s8, s77, 3
    s_add_u32 s8, s8, 0
    v_add_u32 v12, s8, v2
    v_mul_u32_u24 v13, 52, v12
    v_lshrrev_b32 v13, 8, v13
    v_mul_u32_u24 v14, 5, v13
    v_sub_u32 v14, v12, v14
    v_lshlrev_b32 v165, 10, v13
    v_lshl_add_u32 v165, v1, 4, v165
    v_lshrrev_b32 v15, 1, v14
    v_lshl_add_u32 v165, v15, 9, v165
    v_and_b32 v15, 1, v14
    v_lshl_add_u32 v165, v15, 3, v165
    v_cmp_eq_u32 vcc, 4, v14
    s_mov_b64 exec, vcc
    v_lshlrev_b32 v165, 8, v13
    v_lshl_add_u32 v165, v1, 3, v165
    v_add_u32 v165, 4096, v165
    s_mov_b64 exec, -1
    v_add_u32 v165, 77824, v165
    s_lshr_b32 s8, s77, 3
    s_add_u32 s8, s8, 2
    v_add_u32 v12, s8, v2
    v_mul_u32_u24 v13, 52, v12
    v_lshrrev_b32 v13, 8, v13
    v_mul_u32_u24 v14, 5, v13
    v_sub_u32 v14, v12, v14
    v_lshlrev_b32 v166, 10, v13
    v_lshl_add_u32 v166, v1, 4, v166
    v_lshrrev_b32 v15, 1, v14
    v_lshl_add_u32 v166, v15, 9, v166
    v_and_b32 v15, 1, v14
    v_lshl_add_u32 v166, v15, 3, v166
    v_cmp_eq_u32 vcc, 4, v14
    s_mov_b64 exec, vcc
    v_lshlrev_b32 v166, 8, v13
    v_lshl_add_u32 v166, v1, 3, v166
    v_add_u32 v166, 4096, v166
    s_mov_b64 exec, -1
    v_add_u32 v166, 77824, v166
    s_lshl_b32 s9, s3, 2
    s_lshr_b32 s12, 0x21211000, s9
    s_and_b32 s12, s12, 15
    s_lshr_b32 s13, 0x44003032, s9
    s_and_b32 s13, s13, 15
    s_cselect_b32 s52, -1, 0
    s_mov_b32 s53, s52
    s_lshl_b32 s10, s12, 12
    s_lshl_b32 s9, s13, 12
    v_add_u32 v151, s10, v146
    v_add_u32 v152, s9, v146
    s_lshl_b32 s10, s12, 5
    s_lshl_b32 s9, s13, 5
    s_sub_u32 s9, s9, 80
    v_lshlrev_b32 v12, 2, v2
    v_add_u32 v12, s10, v12
    v_add_u32 v13, s9, v1
    v_and_b32 v14, 0xffff, v13
    v_mul_u32_u24 v14, 3277, v14
    v_lshrrev_b32 v14, 16, v14
    v_mul_u32_u24 v15, 80, v13
    s_cmp_eq_u32 s13, 0
    s_cbranch_scc1 PC_z
    v_add_u32 v16, 0, v12
    v_mul_u32_u24 v17, 3277, v16
    v_lshrrev_b32 v17, 16, v17
    v_lshl_add_u32 v147, v16, 2, v15
    v_cmp_eq_u32 s[92:93], v17, v14
    v_add_u32 v16, 8, v12
    v_mul_u32_u24 v17, 3277, v16
    v_lshrrev_b32 v17, 16, v17
    v_lshl_add_u32 v148, v16, 2, v15
    v_cmp_eq_u32 s[94:95], v17, v14
    v_add_u32 v16, 16, v12
    v_mul_u32_u24 v17, 3277, v16
    v_lshrrev_b32 v17, 16, v17
    v_lshl_add_u32 v149, v16, 2, v15
    v_cmp_eq_u32 s[98:99], v17, v14
    v_add_u32 v16, 24, v12
    v_mul_u32_u24 v17, 3277, v16
    v_lshrrev_b32 v17, 16, v17
    v_lshl_add_u32 v150, v16, 2, v15
    v_cmp_eq_u32 s[100:101], v17, v14
    s_branch PC_zd
PC_z:
    v_add_u32 v16, 0, v12
    v_mul_u32_u24 v17, 3277, v16
    v_lshrrev_b32 v17, 16, v17
    v_add_u32 v147, 1, v17
    v_mul_u32_u24 v147, 1600, v147
    v_lshl_add_u32 v147, v16, 2, v147
    v_cmp_gt_u32 s[92:93], 4, v17
    s_and_b32 s92, s92, 1
    s_and_b32 s93, s93, 1
    v_add_u32 v16, 8, v12
    v_mul_u32_u24 v17, 3277, v16
    v_lshrrev_b32 v17, 16, v17
    v_add_u32 v148, 1, v17
    v_mul_u32_u24 v148, 1600, v148
    v_lshl_add_u32 v148, v16, 2, v148
    v_cmp_gt_u32 s[94:95], 4, v17
    s_and_b32 s94, s94, 1
    s_and_b32 s95, s95, 1
    v_add_u32 v16, 16, v12
    v_mul_u32_u24 v17, 3277, v16
    v_lshrrev_b32 v17, 16, v17
    v_add_u32 v149, 1, v17
    v_mul_u32_u24 v149, 1600, v149
    v_lshl_add_u32 v149, v16, 2, v149
    v_cmp_gt_u32 s[98:99], 4, v17
    s_and_b32 s98, s98, 1
    s_and_b32 s99, s99, 1
    v_add_u32 v16, 24, v12
    v_mul_u32_u24 v17, 3277, v16
    v_lshrrev_b32 v17, 16, v17
    v_add_u32 v150, 1, v17
    v_mul_u32_u24 v150, 1600, v150
    v_lshl_add_u32 v150, v16, 2, v150
    v_cmp_gt_u32 s[100:101], 4, v17
    s_and_b32 s100, s100, 1
    s_and_b32 s101, s101, 1
PC_zd:
    v_add_u32 v147, 102400, v147
    v_add_u32 v148, 102400, v148
    v_add_u32 v149, 102400, v149
    v_add_u32 v150, 102400, v150
    v_mov_b32 v64, 0
    v_mov_b32 v65, 0
    v_mov_b32 v66, 0
    v_mov_b32 v67, 0
    v_mov_b32 v68, 0
    v_mov_b32 v69, 0
    v_mov_b32 v70, 0
    v_mov_b32 v71, 0
    v_mov_b32 v72, 0
    v_mov_b32 v73, 0
    v_mov_b32 v74, 0
    v_mov_b32 v75, 0
    v_mov_b32 v76, 0
    v_mov_b32 v77, 0
    v_mov_b32 v78, 0
    v_mov_b32 v79, 0
    v_mov_b32 v80, 0
    v_mov_b32 v81, 0
    v_mov_b32 v82, 0
    v_mov_b32 v83, 0
    v_mov_b32 v84, 0
    v_mov_b32 v85, 0
    v_mov_b32 v86, 0
    v_mov_b32 v87, 0
    v_mov_b32 v88, 0
    v_mov_b32 v89, 0
    v_mov_b32 v90, 0
    v_mov_b32 v91, 0
    v_mov_b32 v92, 0
    v_mov_b32 v93, 0
    v_mov_b32 v94, 0
    v_mov_b32 v95, 0
    v_mov_b32 v96, 0
    v_mov_b32 v97, 0
    v_mov_b32 v98, 0
    v_mov_b32 v99, 0
    v_mov_b32 v100, 0
    v_mov_b32 v101, 0
    v_mov_b32 v102, 0
    v_mov_b32 v103, 0
    v_mov_b32 v104, 0
    v_mov_b32 v105, 0
    v_mov_b32 v106, 0
    v_mov_b32 v107, 0
    v_mov_b32 v108, 0
    v_mov_b32 v109, 0
    v_mov_b32 v110, 0
    v_mov_b32 v111, 0
    v_mov_b32 v167, 0xdddddddd
    s_waitcnt lgkmcnt(0)
    s_mov_b32 s40, s36
    s_mov_b32 s41, s37
    s_mov_b32 s42, 14680064
    s_mov_b32 s43, 0x20000
    s_cmp_lt_u32 s3, 3
    s_cbranch_scc1 A_q
    s_cmp_eq_u32 s3, 5
    s_cbranch_scc1 A_kvpoll
    s_cmp_lt_u32 s3, 6
    s_cbranch_scc1 A_bars
    s_mov_b32 s44, s34
    s_mov_b32 s45, s35
    s_mov_b32 s46, 256
    s_mov_b32 s47, 0x20000
    v_mov_b32 v10, 0
    v_and_b32 v20, 15, v0
    v_lshrrev_b32 v21, 4, v0
    v_xor_b32 v22, v20, v21
    v_lshlrev_b32 v22, 4, v22
    v_lshl_add_u32 v22, v20, 8, v22
    v_add_u32 v22, 116736, v22
    v_xor_b32 v23, 64, v22
    v_xor_b32 v24, 128, v22
    v_xor_b32 v25, 192, v22
    v_bfe_u32 v26, v0, 2, 2
    v_lshl_add_u32 v26, v21, 3, v26
    v_mul_u32_u24 v26, 40, v26
    v_and_b32 v27, 3, v0
    v_lshl_add_u32 v26, v27, 3, v26
    s_lshl_b32 s8, s38, 5
    s_add_u32 s8, s8, 137216
    v_add_u32 v26, s8, v26
    s_lshl_b32 s12, s4, 1
    s_lshr_b32 s8, s5, 2
    s_add_u32 s12, s12, s8
    s_mul_i32 s12, s12, 2816
    s_add_u32 s12, s12, 5242880
    s_bfe_u32 s13, s5, 0x10001
    s_lshl_b32 s55, s4, 4
    s_add_u32 s55, s55, s5
    s_lshl_b32 s55, s55, 1
    s_add_u32 s55, s55, s38
    s_lshl_b32 s55, s55, 2
    s_add_u32 s55, s55, 7438336
    v_and_b32 v27, 1, v21
    s_mov_b32 s56, 0
    s_mov_b64 s[48:49], -1
    v_mov_b32 v12, 0
    v_mov_b32 v13, 0
    v_mov_b32 v14, 0
    v_mov_b32 v15, 0
    s_bitcmp1_b32 s5, 0
    s_cbranch_scc1 M_v
    s_lshl_b32 s8, s13, 4
    v_add_u32 v20, s8, v20
    v_lshlrev_b32 v28, 4, v20
    v_lshl_add_u32 v28, v2, 9, v28
    v_lshl_add_u32 v28, v27, 3, v28
    s_cmp_eq_u32 s3, 6
    s_cbranch_scc1 M_k0
    v_lshlrev_b32 v28, 3, v20
    v_add_u32 v28, 1024, v28
    s_mov_b32 exec_lo, 0xffff0000
    v_lshlrev_b32 v28, 3, v20
    v_add_u32 v28, 2560, v28
    s_mov_b32 exec_lo, -1
    s_mov_b32 s49, 0
M_k0:
    s_barrier
    buffer_load_dword v11, v10, s[44:47], 0 offen sc1
M_kl:
    ds_read_b128 v[80:83], v22
    ds_read_b64_tr_b16 v[84:85], v26 offset:0
    ds_read_b64_tr_b16 v[86:87], v26 offset:160
    v_add_u32 v22, 4096, v22
    s_waitcnt lgkmcnt(9)
    v_mfma_f32_16x16x32_bf16 v[12:15], v[92:95], v[88:91], v[12:15]
    ds_read_b128 v[88:91], v23
    ds_read_b64_tr_b16 v[92:93], v26 offset:1280
    ds_read_b64_tr_b16 v[94:95], v26 offset:1440
    v_add_u32 v23, 4096, v23
    s_waitcnt lgkmcnt(9)
    v_mfma_f32_16x16x32_bf16 v[12:15], v[100:103], v[96:99], v[12:15]
    ds_read_b128 v[96:99], v24
    ds_read_b64_tr_b16 v[100:101], v26 offset:2560
    ds_read_b64_tr_b16 v[102:103], v26 offset:2720
    v_add_u32 v24, 4096, v24
    s_waitcnt lgkmcnt(9)
    v_mfma_f32_16x16x32_bf16 v[12:15], v[108:111], v[104:107], v[12:15]
    ds_read_b128 v[104:107], v25
    ds_read_b64_tr_b16 v[108:109], v26 offset:3840
    ds_read_b64_tr_b16 v[110:111], v26 offset:4000
    v_add_u32 v25, 4096, v25
    s_waitcnt lgkmcnt(9)
    v_mfma_f32_16x16x32_bf16 v[12:15], v[84:87], v[80:83], v[12:15]
    v_add_u32 v26, 5120, v26
    s_add_u32 s56, s56, 1
    s_cmp_lt_u32 s56, 5
    s_cbranch_scc1 M_kl
    s_waitcnt lgkmcnt(6)
    v_mfma_f32_16x16x32_bf16 v[12:15], v[92:95], v[88:91], v[12:15]
    s_waitcnt lgkmcnt(3)
    v_mfma_f32_16x16x32_bf16 v[12:15], v[100:103], v[96:99], v[12:15]
    s_waitcnt lgkmcnt(0)
    v_mfma_f32_16x16x32_bf16 v[12:15], v[108:111], v[104:107], v[12:15]
    s_mov_b32 s8, 0x3ea52b5c
    s_nop 6
    v_pk_mul_f32 v[12:13], v[12:13], s[8:9] op_sel_hi:[1,0]
    v_pk_mul_f32 v[14:15], v[14:15], s[8:9] op_sel_hi:[1,0]
    v_cvt_pk_bf16_f32 v12, v12, v13
    v_cvt_pk_bf16_f32 v13, v14, v15
    s_cmp_eq_u32 s3, 6
    s_cbranch_scc1 M_st
    s_mov_b32 exec_lo, 0xffff0000
    v_mov_b32 v12, 0x3f803f80
    v_mov_b32 v13, 0x3f803f80
    s_mov_b32 exec_lo, 0xcccc0000
    v_mov_b32 v12, 0
    v_mov_b32 v13, 0
    s_branch M_st
M_v:
    s_mul_i32 s8, s13, 640
    s_add_u32 s12, s12, s8
    s_lshl_b32 s8, s38, 8
    s_add_u32 s12, s12, s8
    s_add_u32 s12, s12, 1280
    v_lshrrev_b32 v28, 2, v20
    v_add_u32 v28, 1, v28
    v_and_b32 v28, 2, v28
    v_mul_u32_u24 v28, 6, v28
    v_xor_b32 v28, v20, v28
    v_mul_u32_u24 v29, 320, v2
    v_lshl_add_u32 v29, v27, 3, v29
    v_lshl_add_u32 v28, v28, 4, v29
    s_cmp_eq_u32 s3, 6
    s_cselect_b32 s48, -1, 0x000f000f
    s_mov_b32 s49, s48
    s_barrier
    buffer_load_dword v11, v10, s[44:47], 0 offen sc1
M_vl:
    ds_read_b128 v[80:83], v22
    ds_read_b64_tr_b16 v[84:85], v26 offset:0
    ds_read_b64_tr_b16 v[86:87], v26 offset:160
    v_add_u32 v22, 4096, v22
    s_waitcnt lgkmcnt(9)
    v_mfma_f32_16x16x32_bf16 v[12:15], v[88:91], v[92:95], v[12:15]
    ds_read_b128 v[88:91], v23
    ds_read_b64_tr_b16 v[92:93], v26 offset:1280
    ds_read_b64_tr_b16 v[94:95], v26 offset:1440
    v_add_u32 v23, 4096, v23
    s_waitcnt lgkmcnt(9)
    v_mfma_f32_16x16x32_bf16 v[12:15], v[96:99], v[100:103], v[12:15]
    ds_read_b128 v[96:99], v24
    ds_read_b64_tr_b16 v[100:101], v26 offset:2560
    ds_read_b64_tr_b16 v[102:103], v26 offset:2720
    v_add_u32 v24, 4096, v24
    s_waitcnt lgkmcnt(9)
    v_mfma_f32_16x16x32_bf16 v[12:15], v[104:107], v[108:111], v[12:15]
    ds_read_b128 v[104:107], v25
    ds_read_b64_tr_b16 v[108:109], v26 offset:3840
    ds_read_b64_tr_b16 v[110:111], v26 offset:4000
    v_add_u32 v25, 4096, v25
    s_waitcnt lgkmcnt(9)
    v_mfma_f32_16x16x32_bf16 v[12:15], v[80:83], v[84:87], v[12:15]
    v_add_u32 v26, 5120, v26
    s_add_u32 s56, s56, 1
    s_cmp_lt_u32 s56, 5
    s_cbranch_scc1 M_vl
    s_waitcnt lgkmcnt(6)
    v_mfma_f32_16x16x32_bf16 v[12:15], v[88:91], v[92:95], v[12:15]
    s_waitcnt lgkmcnt(3)
    v_mfma_f32_16x16x32_bf16 v[12:15], v[96:99], v[100:103], v[12:15]
    s_waitcnt lgkmcnt(0)
    v_mfma_f32_16x16x32_bf16 v[12:15], v[104:107], v[108:111], v[12:15]
    s_nop 7
    v_cvt_pk_bf16_f32 v12, v12, v13
    v_cvt_pk_bf16_f32 v13, v14, v15
M_st:
    s_mov_b64 exec, s[48:49]
    buffer_store_dwordx2 v[12:13], v28, s[40:43], s12 offen sc1
    s_mov_b64 exec, -1
    s_barrier
    s_barrier
    s_mov_b32 s9, 0
A_np:
    s_add_u32 s9, s9, 1
    s_waitcnt vmcnt(0)
    v_cmp_eq_u32 vcc, 0, v11
    s_cmp_gt_u32 s9, 131072
    s_cbranch_scc1 A_nd
    s_cbranch_vccz A_nd
    s_sleep 1
    buffer_load_dword v11, v10, s[44:47], 0 offen sc1
    s_branch A_np
A_nd:
    s_mov_b64 exec, 1
    buffer_store_dword v11, v10, s[40:43], s55 offen sc1
    s_mov_b64 exec, -1
    v_mov_b32 v5, 163824
    ds_write_b32 v5, v11
    ds_write_b32 v5, v10 offset:8
    ds_write_b32 v5, v10 offset:4
    s_waitcnt lgkmcnt(0)
    s_branch A_bars8
A_kvpoll:
    v_lshrrev_b32 v20, 1, v0
    v_lshlrev_b32 v20, 7, v20
    v_and_b32 v21, 1, v0
    v_lshl_add_u32 v20, v21, 4, v20
    v_mov_b32 v18, v146
    s_and_b32 s60, s7, 15
    s_mov_b32 s61, 116736
    s_mov_b32 s12, 7438336
    s_mov_b32 s9, 0
    s_barrier
    s_barrier
    s_barrier
    s_barrier
    s_barrier
    s_barrier
    s_barrier
    v_mov_b32 v23, 163824
    ds_read_b32 v22, v23
    s_waitcnt lgkmcnt(0)
    v_readfirstlane_b32 s96, v22
    s_barrier
    s_sleep 3
    buffer_load_dwordx4 v[24:27], v20, s[40:43], s12 offen sc1
    buffer_load_dwordx4 v[28:31], v20, s[40:43], s12 offen offset:32 sc1
    s_barrier
    s_barrier
    s_barrier
    s_mov_b32 s13, 0
A_kq:
    s_add_u32 s9, s9, 1
    s_waitcnt vmcnt(0)
    v_xor_b32 v24, s96, v24
    v_xor_b32 v25, s96, v25
    v_xor_b32 v26, s96, v26
    v_xor_b32 v27, s96, v27
    v_xor_b32 v28, s96, v28
    v_xor_b32 v29, s96, v29
    v_xor_b32 v30, s96, v30
    v_xor_b32 v31, s96, v31
    v_or3_b32 v24, v24, v25, v26
    v_or3_b32 v27, v27, v28, v29
    v_or3_b32 v24, v24, v30, v31
    v_or_b32 v24, v24, v27
    v_cmp_ne_u32 vcc, 0, v24
    s_cmp_gt_u32 s9, 131072
    s_cbranch_scc1 A_kd
    s_cbranch_vccz A_kd
    s_mov_b64 exec, vcc
    s_sleep 8
    buffer_load_dwordx4 v[24:27], v20, s[40:43], s12 offen sc1
    buffer_load_dwordx4 v[28:31], v20, s[40:43], s12 offen offset:32 sc1
    s_cmp_eq_u32 s13, 0
    s_cbranch_scc1 A_kq
    s_barrier
    s_sub_u32 s13, s13, 1
    s_branch A_kq
A_kd:
    s_mov_b64 exec, -1
    s_call_b64 s[62:63], L_issueKV
A_kr:
    s_cmp_eq_u32 s13, 0
    s_cbranch_scc1 A_ke
    s_barrier
    s_sub_u32 s13, s13, 1
    s_branch A_kr
A_ke:
    s_call_b64 s[62:63], L_issueKV
    s_call_b64 s[62:63], L_issueKV
    s_call_b64 s[62:63], L_issueKV
    s_waitcnt vmcnt(33)
    s_branch A_done
A_bars:
    s_barrier
    s_barrier
    s_barrier
A_bars8:
    s_barrier
    s_barrier
    s_barrier
    s_barrier
    s_barrier
    s_barrier
    s_barrier
    s_barrier
    s_waitcnt vmcnt(0)
    s_branch A_done
A_q:
    s_mov_b32 s56, 0
    s_mov_b32 s70, 19456
    s_mov_b32 s74, -97280
    s_mov_b32 s75, -58368
    v_mov_b32 v4, 0
    v_mov_b32 v5, 0
    v_mov_b32 v6, 0
    v_mov_b32 v7, 0
    v_mov_b32 v8, 0
    v_mov_b32 v9, 0
    v_mov_b32 v10, 0
    v_mov_b32 v11, 0
    v_mov_b32 v12, 0
    v_mov_b32 v13, 0
    v_mov_b32 v14, 0
    v_mov_b32 v15, 0
    v_mov_b32 v16, 0
    v_mov_b32 v17, 0
    v_mov_b32 v18, 0
    v_mov_b32 v19, 0
    v_mov_b32 v20, 0
    v_mov_b32 v21, 0
    v_mov_b32 v22, 0
    v_mov_b32 v23, 0
    v_mov_b32 v24, 0
    v_mov_b32 v25, 0
    v_mov_b32 v26, 0
    v_mov_b32 v27, 0
    v_mov_b32 v28, 0
    v_mov_b32 v29, 0
    v_mov_b32 v30, 0
    v_mov_b32 v31, 0
    v_mov_b32 v32, 0
    v_mov_b32 v33, 0
    v_mov_b32 v34, 0
    v_mov_b32 v35, 0
    s_barrier
    s_barrier
    ds_read_b64_tr_b16 v[112:113], v140 offset:0
    ds_read_b64_tr_b16 v[114:115], v140 offset:640
    ds_read_b128 v[116:119], v141 offset:0
    ds_read_b128 v[120:123], v141 offset:4096
    ds_read_b64_tr_b16 v[124:125], v140 offset:2560
    ds_read_b64_tr_b16 v[126:127], v140 offset:3200
    ds_read_b128 v[128:131], v142 offset:0
    ds_read_b128 v[132:135], v142 offset:4096
    ds_read_b64_tr_b16 v[36:37], v140 offset:5120
    ds_read_b64_tr_b16 v[38:39], v140 offset:5760
    ds_read_b128 v[40:43], v143 offset:0
    ds_read_b128 v[44:47], v143 offset:4096
    s_branch A_mid
.p2align 3
A_loop:
    s_waitcnt lgkmcnt(0)
    s_barrier
    v_mfma_f32_32x32x16_bf16 v[4:19], v[36:39], v[40:43], v[4:19]
    ds_read_b64_tr_b16 v[112:113], v140 offset:0
    ds_read_b64_tr_b16 v[114:115], v140 offset:640
    ds_read_b128 v[116:119], v141 offset:0
    v_mfma_f32_32x32x16_bf16 v[20:35], v[36:39], v[44:47], v[20:35]
    ds_read_b128 v[120:123], v141 offset:4096
    ds_read_b64_tr_b16 v[124:125], v140 offset:2560
    ds_read_b64_tr_b16 v[126:127], v140 offset:3200
    v_mfma_f32_32x32x16_bf16 v[4:19], v[48:51], v[52:55], v[4:19]
    ds_read_b128 v[128:131], v142 offset:0
    ds_read_b128 v[132:135], v142 offset:4096
    ds_read_b64_tr_b16 v[36:37], v140 offset:5120
    v_mfma_f32_32x32x16_bf16 v[20:35], v[48:51], v[56:59], v[20:35]
    ds_read_b64_tr_b16 v[38:39], v140 offset:5760
    ds_read_b128 v[40:43], v143 offset:0
    ds_read_b128 v[44:47], v143 offset:4096
A_mid:
    s_add_u32 s56, s56, 1
    s_cmp_eq_u32 s56, 6
    s_cselect_b32 s8, s74, s70
    s_waitcnt lgkmcnt(8)
    v_mfma_f32_32x32x16_bf16 v[4:19], v[112:115], v[116:119], v[4:19]
    ds_read_b64_tr_b16 v[48:49], v140 offset:7680
    ds_read_b64_tr_b16 v[50:51], v140 offset:8320
    s_cmp_lt_u32 s56, 10
    s_cselect_b32 s8, s8, s75
    v_mfma_f32_32x32x16_bf16 v[20:35], v[112:115], v[120:123], v[20:35]
    ds_read_b128 v[52:55], v144 offset:0
    ds_read_b128 v[56:59], v144 offset:4096
    s_waitcnt lgkmcnt(8)
    v_add_u32 v140, s8, v140
    v_mfma_f32_32x32x16_bf16 v[4:19], v[124:127], v[128:131], v[4:19]
    v_add_u32 v141, s8, v141
    v_add_u32 v142, s8, v142
    v_add_u32 v143, s8, v143
    v_add_u32 v144, s8, v144
    v_mfma_f32_32x32x16_bf16 v[20:35], v[124:127], v[132:135], v[20:35]
    s_cbranch_scc1 A_loop
    s_waitcnt lgkmcnt(4)
    v_mfma_f32_32x32x16_bf16 v[4:19], v[36:39], v[40:43], v[4:19]
    s_waitcnt lgkmcnt(0)
    v_mfma_f32_32x32x16_bf16 v[4:19], v[48:51], v[52:55], v[4:19]
    v_mfma_f32_32x32x16_bf16 v[20:35], v[36:39], v[44:47], v[20:35]
    v_mfma_f32_32x32x16_bf16 v[20:35], v[48:51], v[56:59], v[20:35]
    s_nop 9
    v_cvt_pk_bf16_f32 v4, v4, v5
    v_cvt_pk_bf16_f32 v5, v6, v7
    ds_write_b64 v162, v[4:5] offset:0
    v_cvt_pk_bf16_f32 v8, v8, v9
    v_cvt_pk_bf16_f32 v9, v10, v11
    ds_write_b64 v163, v[8:9] offset:0
    v_cvt_pk_bf16_f32 v12, v12, v13
    v_cvt_pk_bf16_f32 v13, v14, v15
    ds_write_b64 v165, v[12:13] offset:0
    v_cvt_pk_bf16_f32 v16, v16, v17
    v_cvt_pk_bf16_f32 v17, v18, v19
    ds_write_b64 v166, v[16:17] offset:0
    v_cvt_pk_bf16_f32 v20, v20, v21
    v_cvt_pk_bf16_f32 v21, v22, v23
    ds_write_b64 v162, v[20:21] offset:5120
    v_cvt_pk_bf16_f32 v24, v24, v25
    v_cvt_pk_bf16_f32 v25, v26, v27
    ds_write_b64 v163, v[24:25] offset:5120
    v_cvt_pk_bf16_f32 v28, v28, v29
    v_cvt_pk_bf16_f32 v29, v30, v31
    ds_write_b64 v165, v[28:29] offset:5120
    v_cvt_pk_bf16_f32 v32, v32, v33
    v_cvt_pk_bf16_f32 v33, v34, v35
    ds_write_b64 v166, v[32:33] offset:5120
A_done:
    s_waitcnt lgkmcnt(0)
    s_barrier
    ds_read_b128 v[60:63], v154
    ds_read_b64 v[50:51], v153
    ds_read_b128 v[44:47], v136 offset:0
    ds_read_b64 v[48:49], v137 offset:0
    ds_read_b128 v[56:59], v136 offset:2816
    ds_read_b128 v[52:55], v138 offset:0
    v_mov_b32 v36, 163824
    ds_read_b32 v39, v36
    s_mov_b32 exec_lo, 0
    s_waitcnt lgkmcnt(3)
    v_mov_b32 v50, 0
    v_mov_b32 v51, 0
    s_mov_b32 exec_lo, -1
    v_mfma_f32_32x32x16_bf16 v[4:19], v[44:47], v[60:63], 0
    v_mfma_f32_32x32x8_bf16 v[4:19], v[48:49], v[50:51], v[4:19]
    ds_read_b64 v[48:49], v137 offset:2816
    ds_read_b128 v[44:47], v136 offset:5632
    s_waitcnt lgkmcnt(2)
    v_mfma_f32_32x32x16_bf16 v[20:35], v[56:59], v[60:63], 0
    v_readfirstlane_b32 s96, v39
    s_nop 6
    v_max3_f32 v36, v4, v5, v6
    v_max3_f32 v36, v36, v7, v8
    v_max3_f32 v36, v36, v9, v10
    v_max3_f32 v36, v36, v11, v12
    v_max3_f32 v36, v36, v13, v14
    v_max3_f32 v36, v36, v15, v16
    v_max3_f32 v36, v36, v17, v18
    v_max_f32 v36, v36, v19
    v_mov_b32 v37, v36
    s_nop 1
    v_permlane32_swap_b32 v36, v37
    s_nop 1
    v_max_f32 v38, v36, v37
    s_mov_b32 exec_lo, 0
    v_sub_f32 v36, 0, v38
    v_and_b32 v37, 0xffff0000, v36
    v_sub_f32 v36, v36, v37
    v_lshrrev_b32 v50, 16, v37
    v_and_b32 v37, 0xffff0000, v36
    v_sub_f32 v36, v36, v37
    v_or_b32 v50, v50, v37
    v_lshrrev_b32 v51, 16, v36
    s_mov_b32 exec_lo, -1
    v_pk_add_f32 v[4:5], v[4:5], v[38:39] op_sel_hi:[1,0] neg_lo:[0,1] neg_hi:[0,1]
    v_pk_add_f32 v[6:7], v[6:7], v[38:39] op_sel_hi:[1,0] neg_lo:[0,1] neg_hi:[0,1]
    v_pk_add_f32 v[8:9], v[8:9], v[38:39] op_sel_hi:[1,0] neg_lo:[0,1] neg_hi:[0,1]
    v_pk_add_f32 v[10:11], v[10:11], v[38:39] op_sel_hi:[1,0] neg_lo:[0,1] neg_hi:[0,1]
    v_pk_add_f32 v[12:13], v[12:13], v[38:39] op_sel_hi:[1,0] neg_lo:[0,1] neg_hi:[0,1]
    v_pk_add_f32 v[14:15], v[14:15], v[38:39] op_sel_hi:[1,0] neg_lo:[0,1] neg_hi:[0,1]
    v_pk_add_f32 v[16:17], v[16:17], v[38:39] op_sel_hi:[1,0] neg_lo:[0,1] neg_hi:[0,1]
    v_pk_add_f32 v[18:19], v[18:19], v[38:39] op_sel_hi:[1,0] neg_lo:[0,1] neg_hi:[0,1]
.p2align 3
    v_exp_f32 v4, v4
    v_exp_f32 v5, v5
    v_exp_f32 v6, v6
    s_waitcnt lgkmcnt(1)
    v_exp_f32_e64 v7, v7
    v_mfma_f32_32x32x8_bf16 v[20:35], v[48:49], v[50:51], v[20:35]
    ds_read_b64 v[48:49], v137 offset:5632
    v_exp_f32 v8, v8
    v_exp_f32 v9, v9
    v_exp_f32 v10, v10
    v_exp_f32 v11, v11
    ds_read_b128 v[56:59], v139 offset:0
    v_exp_f32 v36, v12
    v_exp_f32 v37, v13
    v_exp_f32 v38, v14
    v_exp_f32 v39, v15
    v_smfmac_f32_32x32x32_bf16 v[64:79], v[52:55], v[4:11], v167
    ds_read_b128 v[52:55], v138 offset:2816
    v_exp_f32 v40, v16
    v_exp_f32 v41, v17
    v_exp_f32 v42, v18
    s_waitcnt lgkmcnt(3)
    v_exp_f32_e64 v43, v19
    v_mfma_f32_32x32x16_bf16 v[4:19], v[44:47], v[60:63], 0
    ds_read_b128 v[44:47], v136 offset:8448
    v_exp_f32 v20, v20
    v_exp_f32 v21, v21
    v_exp_f32 v22, v22
    s_waitcnt lgkmcnt(3)
    v_exp_f32_e64 v23, v23
    v_mfma_f32_32x32x8_bf16 v[4:19], v[48:49], v[50:51], v[4:19]
    ds_read_b64 v[48:49], v137 offset:8448
    v_exp_f32 v24, v24
    v_exp_f32 v25, v25
    v_exp_f32 v26, v26
    s_waitcnt lgkmcnt(3)
    v_exp_f32_e64 v27, v27
    v_smfmac_f32_32x32x32_bf16 v[64:79], v[56:59], v[36:43], v167
    ds_read_b128 v[56:59], v139 offset:2816
    v_exp_f32 v36, v28
    v_exp_f32 v37, v29
    v_exp_f32 v38, v30
    s_waitcnt lgkmcnt(3)
    v_exp_f32_e64 v39, v31
    v_smfmac_f32_32x32x32_bf16 v[64:79], v[52:55], v[20:27], v167
    ds_read_b128 v[52:55], v138 offset:5632
    v_exp_f32 v40, v32
    v_exp_f32 v41, v33
    v_exp_f32 v42, v34
    v_exp_f32 v43, v35
    s_waitcnt vmcnt(0)
    s_barrier
    s_waitcnt lgkmcnt(3)
    s_nop 0
    v_mfma_f32_32x32x16_bf16 v[20:35], v[44:47], v[60:63], 0
    ds_read_b128 v[44:47], v136 offset:11264
    v_exp_f32 v4, v4
    v_exp_f32 v5, v5
    v_exp_f32 v6, v6
    s_waitcnt lgkmcnt(3)
    v_exp_f32_e64 v7, v7
    v_mfma_f32_32x32x8_bf16 v[20:35], v[48:49], v[50:51], v[20:35]
    ds_read_b64 v[48:49], v137 offset:11264
    v_exp_f32 v8, v8
    v_exp_f32 v9, v9
    v_exp_f32 v10, v10
    s_waitcnt lgkmcnt(3)
    v_exp_f32_e64 v11, v11
    v_smfmac_f32_32x32x32_bf16 v[64:79], v[56:59], v[36:43], v167
    ds_read_b128 v[56:59], v139 offset:5632
    v_exp_f32 v36, v12
    v_exp_f32 v37, v13
    v_exp_f32 v38, v14
    s_waitcnt lgkmcnt(3)
    v_exp_f32_e64 v39, v15
    v_smfmac_f32_32x32x32_bf16 v[64:79], v[52:55], v[4:11], v167
    ds_read_b128 v[52:55], v138 offset:8448
    v_exp_f32 v40, v16
    v_exp_f32 v41, v17
    v_exp_f32 v42, v18
    s_waitcnt lgkmcnt(3)
    v_exp_f32_e64 v43, v19
    v_mfma_f32_32x32x16_bf16 v[4:19], v[44:47], v[60:63], 0
    ds_read_b128 v[44:47], v136 offset:14080
    v_exp_f32 v20, v20
    v_exp_f32 v21, v21
    v_exp_f32 v22, v22
    s_waitcnt lgkmcnt(3)
    v_exp_f32_e64 v23, v23
    v_mfma_f32_32x32x8_bf16 v[4:19], v[48:49], v[50:51], v[4:19]
    ds_read_b64 v[48:49], v137 offset:14080
    v_exp_f32 v24, v24
    v_exp_f32 v25, v25
    v_exp_f32 v26, v26
    s_waitcnt lgkmcnt(3)
    v_exp_f32_e64 v27, v27
    v_smfmac_f32_32x32x32_bf16 v[64:79], v[56:59], v[36:43], v167
    ds_read_b128 v[56:59], v139 offset:8448
    v_exp_f32 v36, v28
    v_exp_f32 v37, v29
    v_exp_f32 v38, v30
    s_waitcnt lgkmcnt(3)
    v_exp_f32_e64 v39, v31
    v_smfmac_f32_32x32x32_bf16 v[64:79], v[52:55], v[20:27], v167
    ds_read_b128 v[52:55], v138 offset:11264
    v_exp_f32 v40, v32
    v_exp_f32 v41, v33
    v_exp_f32 v42, v34
    s_waitcnt lgkmcnt(3)
    v_exp_f32_e64 v43, v35
    v_mfma_f32_32x32x16_bf16 v[20:35], v[44:47], v[60:63], 0
    ds_read_b128 v[44:47], v136 offset:16896
    v_exp_f32 v4, v4
    v_exp_f32 v5, v5
    v_exp_f32 v6, v6
    s_waitcnt lgkmcnt(3)
    v_exp_f32_e64 v7, v7
    v_mfma_f32_32x32x8_bf16 v[20:35], v[48:49], v[50:51], v[20:35]
    ds_read_b64 v[48:49], v137 offset:16896
    v_exp_f32 v8, v8
    v_exp_f32 v9, v9
    v_exp_f32 v10, v10
    s_waitcnt lgkmcnt(3)
    v_exp_f32_e64 v11, v11
    v_smfmac_f32_32x32x32_bf16 v[64:79], v[56:59], v[36:43], v167
    ds_read_b128 v[56:59], v139 offset:11264
    v_exp_f32 v36, v12
    v_exp_f32 v37, v13
    v_exp_f32 v38, v14
    s_waitcnt lgkmcnt(3)
    v_exp_f32_e64 v39, v15
    v_smfmac_f32_32x32x32_bf16 v[64:79], v[52:55], v[4:11], v167
    ds_read_b128 v[52:55], v138 offset:14080
    v_exp_f32 v40, v16
    v_exp_f32 v41, v17
    v_exp_f32 v42, v18
    v_exp_f32 v43, v19
    s_mov_b64 exec, 1
    v_mov_b32 v3, 1
    v_mov_b32 v164, 163824
    ds_add_u32 v164, v3 offset:4
    s_mov_b64 exec, -1
    s_waitcnt lgkmcnt(4)
    v_mfma_f32_32x32x16_bf16 v[4:19], v[44:47], v[60:63], 0
    ds_read_b128 v[44:47], v136 offset:19712
    v_exp_f32 v20, v20
    v_exp_f32 v21, v21
    v_exp_f32 v22, v22
    s_waitcnt lgkmcnt(4)
    v_exp_f32_e64 v23, v23
    v_mfma_f32_32x32x8_bf16 v[4:19], v[48:49], v[50:51], v[4:19]
    ds_read_b64 v[48:49], v137 offset:19712
    v_exp_f32 v24, v24
    v_exp_f32 v25, v25
    v_exp_f32 v26, v26
    s_waitcnt lgkmcnt(4)
    v_exp_f32_e64 v27, v27
    v_smfmac_f32_32x32x32_bf16 v[64:79], v[56:59], v[36:43], v167
    ds_read_b128 v[56:59], v139 offset:14080
    v_exp_f32 v36, v28
    v_exp_f32 v37, v29
    v_exp_f32 v38, v30
    s_waitcnt lgkmcnt(4)
    v_exp_f32_e64 v39, v31
    v_smfmac_f32_32x32x32_bf16 v[64:79], v[52:55], v[20:27], v167
    ds_read_b128 v[52:55], v138 offset:16896
    v_exp_f32 v40, v32
    v_exp_f32 v41, v33
    v_exp_f32 v42, v34
    s_waitcnt lgkmcnt(3)
    v_exp_f32_e64 v43, v35
    v_mfma_f32_32x32x16_bf16 v[20:35], v[44:47], v[60:63], 0
    ds_read_b128 v[44:47], v136 offset:22528
    v_exp_f32 v4, v4
    v_exp_f32 v5, v5
    v_exp_f32 v6, v6
    s_waitcnt lgkmcnt(3)
    v_exp_f32_e64 v7, v7
    v_mfma_f32_32x32x8_bf16 v[20:35], v[48:49], v[50:51], v[20:35]
    ds_read_b64 v[48:49], v137 offset:22528
    v_exp_f32 v8, v8
    v_exp_f32 v9, v9
    v_exp_f32 v10, v10
    s_waitcnt lgkmcnt(3)
    v_exp_f32_e64 v11, v11
    v_smfmac_f32_32x32x32_bf16 v[64:79], v[56:59], v[36:43], v167
    ds_read_b128 v[56:59], v139 offset:16896
    v_exp_f32 v36, v12
    v_exp_f32 v37, v13
    v_exp_f32 v38, v14
    s_waitcnt lgkmcnt(3)
    v_exp_f32_e64 v39, v15
    v_smfmac_f32_32x32x32_bf16 v[64:79], v[52:55], v[4:11], v167
    ds_read_b128 v[52:55], v138 offset:19712
    v_exp_f32 v40, v16
    v_exp_f32 v41, v17
    v_exp_f32 v42, v18
    s_waitcnt lgkmcnt(3)
    v_exp_f32_e64 v43, v19
    v_mfma_f32_32x32x16_bf16 v[4:19], v[44:47], v[60:63], 0
    ds_read_b128 v[44:47], v136 offset:25344
    v_exp_f32 v20, v20
    v_exp_f32 v21, v21
    v_exp_f32 v22, v22
    s_waitcnt lgkmcnt(3)
    v_exp_f32_e64 v23, v23
    v_mfma_f32_32x32x8_bf16 v[4:19], v[48:49], v[50:51], v[4:19]
    ds_read_b64 v[48:49], v137 offset:25344
    v_exp_f32 v24, v24
    v_exp_f32 v25, v25
    v_exp_f32 v26, v26
    s_waitcnt lgkmcnt(3)
    v_exp_f32_e64 v27, v27
    v_smfmac_f32_32x32x32_bf16 v[64:79], v[56:59], v[36:43], v167
    ds_read_b128 v[56:59], v139 offset:19712
    v_exp_f32 v36, v28
    v_exp_f32 v37, v29
    v_exp_f32 v38, v30
    s_waitcnt lgkmcnt(3)
    v_exp_f32_e64 v39, v31
    v_smfmac_f32_32x32x32_bf16 v[64:79], v[52:55], v[20:27], v167
    ds_read_b128 v[52:55], v138 offset:22528
    v_exp_f32 v40, v32
    v_exp_f32 v41, v33
    v_exp_f32 v42, v34
    s_waitcnt lgkmcnt(3)
    v_exp_f32_e64 v43, v35
    v_mfma_f32_32x32x16_bf16 v[20:35], v[44:47], v[60:63], 0
    ds_read_b128 v[44:47], v136 offset:28160
    v_exp_f32 v4, v4
    v_exp_f32 v5, v5
    v_exp_f32 v6, v6
    s_waitcnt lgkmcnt(3)
    v_exp_f32_e64 v7, v7
    v_mfma_f32_32x32x8_bf16 v[20:35], v[48:49], v[50:51], v[20:35]
    ds_read_b64 v[48:49], v137 offset:28160
    v_exp_f32 v8, v8
    v_exp_f32 v9, v9
    v_exp_f32 v10, v10
    s_waitcnt lgkmcnt(3)
    v_exp_f32_e64 v11, v11
    v_smfmac_f32_32x32x32_bf16 v[64:79], v[56:59], v[36:43], v167
    ds_read_b128 v[56:59], v139 offset:22528
    v_exp_f32 v36, v12
    v_exp_f32 v37, v13
    v_exp_f32 v38, v14
    s_waitcnt lgkmcnt(3)
    v_exp_f32_e64 v39, v15
    v_smfmac_f32_32x32x32_bf16 v[64:79], v[52:55], v[4:11], v167
    ds_read_b128 v[52:55], v138 offset:25344
    v_exp_f32 v40, v16
    v_exp_f32 v41, v17
    v_exp_f32 v42, v18
    s_waitcnt lgkmcnt(3)
    v_exp_f32_e64 v43, v19
    v_mfma_f32_32x32x16_bf16 v[4:19], v[44:47], v[60:63], 0
    ds_read_b128 v[44:47], v136 offset:30976
    v_exp_f32 v20, v20
    v_exp_f32 v21, v21
    v_exp_f32 v22, v22
    s_waitcnt lgkmcnt(3)
    v_exp_f32_e64 v23, v23
    v_mfma_f32_32x32x8_bf16 v[4:19], v[48:49], v[50:51], v[4:19]
    ds_read_b64 v[48:49], v137 offset:30976
    v_exp_f32 v24, v24
    v_exp_f32 v25, v25
    v_exp_f32 v26, v26
    s_waitcnt lgkmcnt(3)
    v_exp_f32_e64 v27, v27
    v_smfmac_f32_32x32x32_bf16 v[64:79], v[56:59], v[36:43], v167
    ds_read_b128 v[56:59], v139 offset:25344
    v_exp_f32 v36, v28
    v_exp_f32 v37, v29
    v_exp_f32 v38, v30
    s_waitcnt lgkmcnt(3)
    v_exp_f32_e64 v39, v31
    v_smfmac_f32_32x32x32_bf16 v[64:79], v[52:55], v[20:27], v167
    ds_read_b128 v[52:55], v138 offset:28160
    v_exp_f32 v40, v32
    v_exp_f32 v41, v33
    v_exp_f32 v42, v34
    v_exp_f32 v43, v35
    s_mov_b32 s70, 38912
    s_mov_b32 s74, -77824
    s_cmp_ge_u32 s3, 3
    s_cbranch_scc1 FU_C
.p2align 3
FU_R:
    s_waitcnt lgkmcnt(3)
    s_barrier
    v_mfma_f32_32x32x16_bf16 v[20:35], v[44:47], v[60:63], 0
    ds_read_b128 v[44:47], v136 offset:33792
    ds_read_b64_tr_b16 v[112:113], v140 offset:0
    ds_read_b64_tr_b16 v[114:115], v140 offset:640
    ds_read_b128 v[116:119], v141 offset:0
    ds_read_b128 v[120:123], v141 offset:4096
    v_exp_f32 v4, v4
    v_exp_f32 v5, v5
    v_exp_f32 v6, v6
    s_waitcnt lgkmcnt(7)
    v_exp_f32_e64 v7, v7
    v_mfma_f32_32x32x8_bf16 v[20:35], v[48:49], v[50:51], v[20:35]
    ds_read_b64 v[48:49], v137 offset:33792
    ds_read_b64_tr_b16 v[124:125], v140 offset:2560
    ds_read_b64_tr_b16 v[126:127], v140 offset:3200
    ds_read_b128 v[128:131], v142 offset:0
    ds_read_b128 v[132:135], v142 offset:4096
    v_exp_f32 v8, v8
    v_exp_f32 v9, v9
    v_exp_f32 v10, v10
    s_waitcnt lgkmcnt(11)
    v_exp_f32_e64 v11, v11
    v_smfmac_f32_32x32x32_bf16 v[64:79], v[56:59], v[36:43], v167
    ds_read_b128 v[56:59], v139 offset:28160
    v_exp_f32 v36, v12
    v_exp_f32 v37, v13
    v_exp_f32 v38, v14
    s_waitcnt lgkmcnt(11)
    v_exp_f32_e64 v39, v15
    v_smfmac_f32_32x32x32_bf16 v[64:79], v[52:55], v[4:11], v167
    ds_read_b128 v[52:55], v138 offset:30976
    v_exp_f32 v40, v16
    v_exp_f32 v41, v17
    v_exp_f32 v42, v18
    v_exp_f32 v43, v19
    v_add_u32 v141, s70, v141
    v_add_u32 v142, s70, v142
    s_waitcnt lgkmcnt(11)
    s_nop 0
    v_mfma_f32_32x32x16_bf16 v[4:19], v[44:47], v[60:63], 0
    ds_read_b128 v[44:47], v136 offset:36608
    v_exp_f32 v20, v20
    v_exp_f32 v21, v21
    v_exp_f32 v22, v22
    s_waitcnt lgkmcnt(7)
    v_exp_f32_e64 v23, v23
    v_mfma_f32_32x32x8_bf16 v[4:19], v[48:49], v[50:51], v[4:19]
    ds_read_b64 v[48:49], v137 offset:36608
    v_exp_f32 v24, v24
    v_exp_f32 v25, v25
    v_exp_f32 v26, v26
    s_waitcnt lgkmcnt(3)
    v_exp_f32_e64 v27, v27
    v_smfmac_f32_32x32x32_bf16 v[64:79], v[56:59], v[36:43], v167
    ds_read_b128 v[56:59], v139 offset:30976
    v_exp_f32 v36, v28
    v_exp_f32 v37, v29
    v_exp_f32 v38, v30
    s_waitcnt lgkmcnt(3)
    v_exp_f32_e64 v39, v31
    v_smfmac_f32_32x32x32_bf16 v[64:79], v[52:55], v[20:27], v167
    ds_read_b128 v[52:55], v138 offset:33792
    v_exp_f32 v40, v32
    v_exp_f32 v41, v33
    v_exp_f32 v42, v34
    s_waitcnt lgkmcnt(3)
    v_exp_f32_e64 v43, v35
    v_mfma_f32_32x32x16_bf16 v[20:35], v[44:47], v[60:63], 0
    ds_read_b128 v[44:47], v136 offset:39424
    v_exp_f32 v4, v4
    v_exp_f32 v5, v5
    v_mfma_f32_32x32x16_bf16 v[96:111], v[112:115], v[120:123], 0
    ds_read_b128 v[120:123], v143 offset:4096
    v_exp_f32 v6, v6
    v_exp_f32 v7, v7
    s_waitcnt lgkmcnt(4)
    v_exp_f32 v8, v8
    v_mfma_f32_32x32x8_bf16 v[20:35], v[48:49], v[50:51], v[20:35]
    ds_read_b64 v[48:49], v137 offset:39424
    v_exp_f32 v9, v9
    v_exp_f32 v10, v10
    s_waitcnt lgkmcnt(4)
    v_exp_f32 v11, v11
    v_smfmac_f32_32x32x32_bf16 v[64:79], v[56:59], v[36:43], v167
    ds_read_b128 v[56:59], v139 offset:33792
    v_exp_f32 v36, v12
    v_exp_f32 v37, v13
    v_exp_f32_e64 v38, v14
    v_mfma_f32_32x32x16_bf16 v[80:95], v[112:115], v[116:119], 0
    ds_read_b128 v[116:119], v143 offset:0
    ds_read_b64_tr_b16 v[112:113], v140 offset:5120
    ds_read_b64_tr_b16 v[114:115], v140 offset:5760
    v_exp_f32 v39, v15
    v_exp_f32 v40, v16
    s_waitcnt lgkmcnt(7)
    v_exp_f32 v41, v17
    v_smfmac_f32_32x32x32_bf16 v[64:79], v[52:55], v[4:11], v167
    ds_read_b128 v[52:55], v138 offset:36608
    v_exp_f32 v42, v18
    v_exp_f32 v43, v19
    v_add_u32 v143, s70, v143
    s_waitcnt lgkmcnt(7)
    v_mfma_f32_32x32x16_bf16 v[4:19], v[44:47], v[60:63], 0
    ds_read_b128 v[44:47], v136 offset:42240
    v_exp_f32 v20, v20
    v_exp_f32 v21, v21
    v_mfma_f32_32x32x16_bf16 v[96:111], v[124:127], v[132:135], v[96:111]
    ds_read_b128 v[132:135], v144 offset:4096
    v_exp_f32 v22, v22
    v_exp_f32 v23, v23
    s_waitcnt lgkmcnt(7)
    v_exp_f32 v24, v24
    v_mfma_f32_32x32x8_bf16 v[4:19], v[48:49], v[50:51], v[4:19]
    ds_read_b64 v[48:49], v137 offset:42240
    v_exp_f32 v25, v25
    v_exp_f32 v26, v26
    s_waitcnt lgkmcnt(7)
    v_exp_f32 v27, v27
    v_smfmac_f32_32x32x32_bf16 v[64:79], v[56:59], v[36:43], v167
    ds_read_b128 v[56:59], v139 offset:36608
    v_exp_f32 v36, v28
    v_exp_f32 v37, v29
    v_exp_f32_e64 v38, v30
    v_mfma_f32_32x32x16_bf16 v[80:95], v[124:127], v[128:131], v[80:95]
    ds_read_b128 v[128:131], v144 offset:0
    ds_read_b64_tr_b16 v[124:125], v140 offset:7680
    ds_read_b64_tr_b16 v[126:127], v140 offset:8320
    v_exp_f32 v39, v31
    v_exp_f32 v40, v32
    s_waitcnt lgkmcnt(7)
    v_exp_f32 v41, v33
    v_smfmac_f32_32x32x32_bf16 v[64:79], v[52:55], v[20:27], v167
    ds_read_b128 v[52:55], v138 offset:39424
    v_exp_f32 v42, v34
    v_exp_f32 v43, v35
    v_add_u32 v144, s70, v144
    v_add_u32 v140, s70, v140
    s_waitcnt lgkmcnt(1)
    s_barrier
    v_mfma_f32_32x32x16_bf16 v[20:35], v[44:47], v[60:63], 0
    ds_read_b128 v[44:47], v136 offset:0
    v_exp_f32 v4, v4
    v_exp_f32 v5, v5
    v_smfmac_f32_32x32x32_bf16 v[64:79], v[56:59], v[36:43], v167
    ds_read_b128 v[56:59], v139 offset:39424
    v_exp_f32_e64 v6, v6
    v_mfma_f32_32x32x8_bf16 v[20:35], v[48:49], v[50:51], v[20:35]
    ds_read_b64 v[48:49], v137 offset:0
    v_exp_f32 v7, v7
    v_exp_f32 v8, v8
    v_mfma_f32_32x32x16_bf16 v[80:95], v[124:127], v[128:131], v[80:95]
    ds_read_b128 v[128:131], v142 offset:0
    v_exp_f32 v9, v9
    v_exp_f32 v10, v10
    v_mfma_f32_32x32x16_bf16 v[96:111], v[112:115], v[120:123], v[96:111]
    ds_read_b128 v[120:123], v141 offset:4096
    v_exp_f32 v11, v11
    v_exp_f32 v36, v12
    v_exp_f32_e64 v37, v13
    v_mfma_f32_32x32x16_bf16 v[96:111], v[124:127], v[132:135], v[96:111]
    ds_read_b128 v[132:135], v142 offset:4096
    ds_read_b64_tr_b16 v[124:125], v140 offset:2560
    ds_read_b64_tr_b16 v[126:127], v140 offset:3200
    v_exp_f32_e64 v38, v14
    v_mfma_f32_32x32x16_bf16 v[80:95], v[112:115], v[116:119], v[80:95]
    ds_read_b128 v[116:119], v141 offset:0
    ds_read_b64_tr_b16 v[112:113], v140 offset:0
    ds_read_b64_tr_b16 v[114:115], v140 offset:640
    v_exp_f32 v39, v15
    v_exp_f32 v40, v16
    s_waitcnt lgkmcnt(11)
    v_exp_f32 v41, v17
    v_smfmac_f32_32x32x32_bf16 v[64:79], v[52:55], v[4:11], v167
    ds_read_b128 v[52:55], v138 offset:42240
    v_exp_f32 v42, v18
    v_exp_f32 v43, v19
    v_add_u32 v141, s70, v141
    v_add_u32 v142, s70, v142
    s_waitcnt lgkmcnt(11)
    s_nop 0
    v_mfma_f32_32x32x16_bf16 v[4:19], v[44:47], v[60:63], 0
    ds_read_b128 v[44:47], v136 offset:2816
    v_exp_f32 v20, v20
    s_waitcnt lgkmcnt(2)
    v_exp_f32_e64 v21, v21
    v_mfma_f32_32x32x16_bf16 v[96:111], v[112:115], v[120:123], v[96:111]
    ds_read_b128 v[120:123], v143 offset:4096
    v_exp_f32 v22, v22
    v_exp_f32 v23, v23
    v_exp_f32_e64 v24, v24
    v_mfma_f32_32x32x8_bf16 v[4:19], v[48:49], v[50:51], v[4:19]
    ds_read_b64 v[48:49], v137 offset:2816
    v_exp_f32 v25, v25
    v_exp_f32 v26, v26
    v_exp_f32_e64 v27, v27
    v_smfmac_f32_32x32x32_bf16 v[64:79], v[56:59], v[36:43], v167
    ds_read_b128 v[56:59], v139 offset:42240
    v_exp_f32 v36, v28
    v_exp_f32 v37, v29
    v_exp_f32_e64 v38, v30
    v_mfma_f32_32x32x16_bf16 v[80:95], v[112:115], v[116:119], v[80:95]
    ds_read_b128 v[116:119], v143 offset:0
    ds_read_b64_tr_b16 v[112:113], v140 offset:5120
    ds_read_b64_tr_b16 v[114:115], v140 offset:5760
    v_exp_f32 v39, v31
    v_exp_f32 v40, v32
    s_waitcnt lgkmcnt(7)
    v_exp_f32 v41, v33
    v_smfmac_f32_32x32x32_bf16 v[64:79], v[52:55], v[20:27], v167
    ds_read_b128 v[52:55], v138 offset:0
    v_exp_f32 v42, v34
    v_exp_f32 v43, v35
    v_add_u32 v143, s70, v143
    s_waitcnt lgkmcnt(7)
    v_mfma_f32_32x32x16_bf16 v[20:35], v[44:47], v[60:63], 0
    ds_read_b128 v[44:47], v136 offset:5632
    v_exp_f32 v4, v4
    v_exp_f32 v5, v5
    v_mfma_f32_32x32x16_bf16 v[96:111], v[124:127], v[132:135], v[96:111]
    ds_read_b128 v[132:135], v144 offset:4096
    v_exp_f32 v6, v6
    v_exp_f32 v7, v7
    s_waitcnt lgkmcnt(7)
    v_exp_f32 v8, v8
    v_mfma_f32_32x32x8_bf16 v[20:35], v[48:49], v[50:51], v[20:35]
    ds_read_b64 v[48:49], v137 offset:5632
    v_exp_f32 v9, v9
    v_exp_f32 v10, v10
    s_waitcnt lgkmcnt(7)
    v_exp_f32 v11, v11
    v_smfmac_f32_32x32x32_bf16 v[64:79], v[56:59], v[36:43], v167
    ds_read_b128 v[56:59], v139 offset:0
    v_exp_f32 v36, v12
    v_exp_f32 v37, v13
    v_exp_f32_e64 v38, v14
    v_mfma_f32_32x32x16_bf16 v[80:95], v[124:127], v[128:131], v[80:95]
    ds_read_b128 v[128:131], v144 offset:0
    ds_read_b64_tr_b16 v[124:125], v140 offset:7680
    ds_read_b64_tr_b16 v[126:127], v140 offset:8320
    v_exp_f32 v39, v15
    v_exp_f32 v40, v16
    s_waitcnt lgkmcnt(7)
    v_exp_f32 v41, v17
    v_smfmac_f32_32x32x32_bf16 v[64:79], v[52:55], v[4:11], v167
    ds_read_b128 v[52:55], v138 offset:2816
    v_exp_f32 v42, v18
    v_exp_f32 v43, v19
    v_add_u32 v144, s70, v144
    v_add_u32 v140, s70, v140
    s_waitcnt lgkmcnt(1)
    s_barrier
    v_mfma_f32_32x32x16_bf16 v[4:19], v[44:47], v[60:63], 0
    ds_read_b128 v[44:47], v136 offset:8448
    v_exp_f32 v20, v20
    v_exp_f32 v21, v21
    v_smfmac_f32_32x32x32_bf16 v[64:79], v[56:59], v[36:43], v167
    ds_read_b128 v[56:59], v139 offset:2816
    v_exp_f32_e64 v22, v22
    v_mfma_f32_32x32x8_bf16 v[4:19], v[48:49], v[50:51], v[4:19]
    ds_read_b64 v[48:49], v137 offset:8448
    v_exp_f32 v23, v23
    v_exp_f32 v24, v24
    v_mfma_f32_32x32x16_bf16 v[80:95], v[124:127], v[128:131], v[80:95]
    ds_read_b128 v[128:131], v142 offset:0
    v_exp_f32 v25, v25
    v_exp_f32 v26, v26
    v_mfma_f32_32x32x16_bf16 v[96:111], v[112:115], v[120:123], v[96:111]
    ds_read_b128 v[120:123], v141 offset:4096
    v_exp_f32 v27, v27
    v_exp_f32 v36, v28
    v_exp_f32_e64 v37, v29
    v_mfma_f32_32x32x16_bf16 v[96:111], v[124:127], v[132:135], v[96:111]
    ds_read_b128 v[132:135], v142 offset:4096
    ds_read_b64_tr_b16 v[124:125], v140 offset:2560
    ds_read_b64_tr_b16 v[126:127], v140 offset:3200
    v_exp_f32_e64 v38, v30
    v_mfma_f32_32x32x16_bf16 v[80:95], v[112:115], v[116:119], v[80:95]
    ds_read_b128 v[116:119], v141 offset:0
    ds_read_b64_tr_b16 v[112:113], v140 offset:0
    ds_read_b64_tr_b16 v[114:115], v140 offset:640
    v_exp_f32 v39, v31
    v_exp_f32 v40, v32
    s_waitcnt lgkmcnt(11)
    v_exp_f32 v41, v33
    v_smfmac_f32_32x32x32_bf16 v[64:79], v[52:55], v[20:27], v167
    ds_read_b128 v[52:55], v138 offset:5632
    v_exp_f32 v42, v34
    v_exp_f32 v43, v35
    v_add_u32 v141, s74, v141
    v_add_u32 v142, s74, v142
    s_waitcnt lgkmcnt(11)
    s_nop 0
    v_mfma_f32_32x32x16_bf16 v[20:35], v[44:47], v[60:63], 0
    ds_read_b128 v[44:47], v136 offset:11264
    v_exp_f32 v4, v4
    s_waitcnt lgkmcnt(2)
    v_exp_f32_e64 v5, v5
    v_mfma_f32_32x32x16_bf16 v[96:111], v[112:115], v[120:123], v[96:111]
    ds_read_b128 v[120:123], v143 offset:4096
    v_exp_f32 v6, v6
    v_exp_f32 v7, v7
    v_exp_f32_e64 v8, v8
    v_mfma_f32_32x32x8_bf16 v[20:35], v[48:49], v[50:51], v[20:35]
    ds_read_b64 v[48:49], v137 offset:11264
    v_exp_f32 v9, v9
    v_exp_f32 v10, v10
    v_exp_f32_e64 v11, v11
    v_smfmac_f32_32x32x32_bf16 v[64:79], v[56:59], v[36:43], v167
    ds_read_b128 v[56:59], v139 offset:5632
    v_exp_f32 v36, v12
    v_exp_f32 v37, v13
    v_exp_f32_e64 v38, v14
    v_mfma_f32_32x32x16_bf16 v[80:95], v[112:115], v[116:119], v[80:95]
    ds_read_b128 v[116:119], v143 offset:0
    ds_read_b64_tr_b16 v[112:113], v140 offset:5120
    ds_read_b64_tr_b16 v[114:115], v140 offset:5760
    v_exp_f32 v39, v15
    v_exp_f32 v40, v16
    s_waitcnt lgkmcnt(7)
    v_exp_f32 v41, v17
    v_smfmac_f32_32x32x32_bf16 v[64:79], v[52:55], v[4:11], v167
    ds_read_b128 v[52:55], v138 offset:8448
    v_exp_f32 v42, v18
    v_exp_f32 v43, v19
    v_add_u32 v143, s74, v143
    s_waitcnt lgkmcnt(7)
    v_mfma_f32_32x32x16_bf16 v[4:19], v[44:47], v[60:63], 0
    ds_read_b128 v[44:47], v136 offset:14080
    v_exp_f32 v20, v20
    v_exp_f32 v21, v21
    v_mfma_f32_32x32x16_bf16 v[96:111], v[124:127], v[132:135], v[96:111]
    ds_read_b128 v[132:135], v144 offset:4096
    v_exp_f32 v22, v22
    v_exp_f32 v23, v23
    s_waitcnt lgkmcnt(7)
    v_exp_f32 v24, v24
    v_mfma_f32_32x32x8_bf16 v[4:19], v[48:49], v[50:51], v[4:19]
    ds_read_b64 v[48:49], v137 offset:14080
    v_exp_f32 v25, v25
    v_exp_f32 v26, v26
    s_waitcnt lgkmcnt(7)
    v_exp_f32 v27, v27
    v_smfmac_f32_32x32x32_bf16 v[64:79], v[56:59], v[36:43], v167
    ds_read_b128 v[56:59], v139 offset:8448
    v_exp_f32 v36, v28
    v_exp_f32 v37, v29
    v_exp_f32_e64 v38, v30
    v_mfma_f32_32x32x16_bf16 v[80:95], v[124:127], v[128:131], v[80:95]
    ds_read_b128 v[128:131], v144 offset:0
    ds_read_b64_tr_b16 v[124:125], v140 offset:7680
    ds_read_b64_tr_b16 v[126:127], v140 offset:8320
    v_exp_f32 v39, v31
    v_exp_f32 v40, v32
    s_waitcnt lgkmcnt(7)
    v_exp_f32 v41, v33
    v_smfmac_f32_32x32x32_bf16 v[64:79], v[52:55], v[20:27], v167
    ds_read_b128 v[52:55], v138 offset:11264
    v_exp_f32 v42, v34
    v_exp_f32 v43, v35
    v_add_u32 v144, s74, v144
    v_add_u32 v140, s74, v140
    s_waitcnt lgkmcnt(1)
    s_barrier
    v_mfma_f32_32x32x16_bf16 v[20:35], v[44:47], v[60:63], 0
    ds_read_b128 v[44:47], v136 offset:16896
    v_exp_f32 v4, v4
    v_exp_f32 v5, v5
    v_smfmac_f32_32x32x32_bf16 v[64:79], v[56:59], v[36:43], v167
    ds_read_b128 v[56:59], v139 offset:11264
    v_exp_f32_e64 v6, v6
    v_mfma_f32_32x32x8_bf16 v[20:35], v[48:49], v[50:51], v[20:35]
    ds_read_b64 v[48:49], v137 offset:16896
    v_exp_f32 v7, v7
    v_exp_f32 v8, v8
    v_mfma_f32_32x32x16_bf16 v[80:95], v[124:127], v[128:131], v[80:95]
    ds_read_b128 v[128:131], v142 offset:0
    v_exp_f32 v9, v9
    v_exp_f32 v10, v10
    v_mfma_f32_32x32x16_bf16 v[96:111], v[112:115], v[120:123], v[96:111]
    ds_read_b128 v[120:123], v141 offset:4096
    v_exp_f32 v11, v11
    v_exp_f32 v36, v12
    v_exp_f32_e64 v37, v13
    v_mfma_f32_32x32x16_bf16 v[96:111], v[124:127], v[132:135], v[96:111]
    ds_read_b128 v[132:135], v142 offset:4096
    ds_read_b64_tr_b16 v[124:125], v140 offset:2560
    ds_read_b64_tr_b16 v[126:127], v140 offset:3200
    v_exp_f32_e64 v38, v14
    v_mfma_f32_32x32x16_bf16 v[80:95], v[112:115], v[116:119], v[80:95]
    ds_read_b128 v[116:119], v141 offset:0
    ds_read_b64_tr_b16 v[112:113], v140 offset:0
    ds_read_b64_tr_b16 v[114:115], v140 offset:640
    v_exp_f32 v39, v15
    v_exp_f32 v40, v16
    s_waitcnt lgkmcnt(11)
    v_exp_f32 v41, v17
    v_smfmac_f32_32x32x32_bf16 v[64:79], v[52:55], v[4:11], v167
    ds_read_b128 v[52:55], v138 offset:14080
    v_exp_f32 v42, v18
    v_exp_f32 v43, v19
    v_add_u32 v141, s70, v141
    v_add_u32 v142, s70, v142
    s_waitcnt lgkmcnt(11)
    s_nop 0
    v_mfma_f32_32x32x16_bf16 v[4:19], v[44:47], v[60:63], 0
    ds_read_b128 v[44:47], v136 offset:19712
    v_exp_f32 v20, v20
    s_waitcnt lgkmcnt(2)
    v_exp_f32_e64 v21, v21
    v_mfma_f32_32x32x16_bf16 v[96:111], v[112:115], v[120:123], v[96:111]
    ds_read_b128 v[120:123], v143 offset:4096
    v_exp_f32 v22, v22
    v_exp_f32 v23, v23
    v_exp_f32_e64 v24, v24
    v_mfma_f32_32x32x8_bf16 v[4:19], v[48:49], v[50:51], v[4:19]
    ds_read_b64 v[48:49], v137 offset:19712
    v_exp_f32 v25, v25
    v_exp_f32 v26, v26
    v_exp_f32_e64 v27, v27
    v_smfmac_f32_32x32x32_bf16 v[64:79], v[56:59], v[36:43], v167
    ds_read_b128 v[56:59], v139 offset:14080
    v_exp_f32 v36, v28
    v_exp_f32 v37, v29
    v_exp_f32_e64 v38, v30
    v_mfma_f32_32x32x16_bf16 v[80:95], v[112:115], v[116:119], v[80:95]
    ds_read_b128 v[116:119], v143 offset:0
    ds_read_b64_tr_b16 v[112:113], v140 offset:5120
    ds_read_b64_tr_b16 v[114:115], v140 offset:5760
    v_exp_f32 v39, v31
    v_exp_f32 v40, v32
    s_waitcnt lgkmcnt(7)
    v_exp_f32 v41, v33
    v_smfmac_f32_32x32x32_bf16 v[64:79], v[52:55], v[20:27], v167
    ds_read_b128 v[52:55], v138 offset:16896
    v_exp_f32 v42, v34
    v_exp_f32 v43, v35
    v_add_u32 v143, s70, v143
    s_waitcnt lgkmcnt(7)
    v_mfma_f32_32x32x16_bf16 v[20:35], v[44:47], v[60:63], 0
    ds_read_b128 v[44:47], v136 offset:22528
    v_exp_f32 v4, v4
    v_exp_f32 v5, v5
    v_mfma_f32_32x32x16_bf16 v[96:111], v[124:127], v[132:135], v[96:111]
    ds_read_b128 v[132:135], v144 offset:4096
    v_exp_f32 v6, v6
    v_exp_f32 v7, v7
    s_waitcnt lgkmcnt(7)
    v_exp_f32 v8, v8
    v_mfma_f32_32x32x8_bf16 v[20:35], v[48:49], v[50:51], v[20:35]
    ds_read_b64 v[48:49], v137 offset:22528
    v_exp_f32 v9, v9
    v_exp_f32 v10, v10
    s_waitcnt lgkmcnt(7)
    v_exp_f32 v11, v11
    v_smfmac_f32_32x32x32_bf16 v[64:79], v[56:59], v[36:43], v167
    ds_read_b128 v[56:59], v139 offset:16896
    v_exp_f32 v36, v12
    v_exp_f32 v37, v13
    v_exp_f32_e64 v38, v14
    v_mfma_f32_32x32x16_bf16 v[80:95], v[124:127], v[128:131], v[80:95]
    ds_read_b128 v[128:131], v144 offset:0
    ds_read_b64_tr_b16 v[124:125], v140 offset:7680
    ds_read_b64_tr_b16 v[126:127], v140 offset:8320
    v_exp_f32 v39, v15
    v_exp_f32 v40, v16
    s_waitcnt lgkmcnt(7)
    v_exp_f32 v41, v17
    v_smfmac_f32_32x32x32_bf16 v[64:79], v[52:55], v[4:11], v167
    ds_read_b128 v[52:55], v138 offset:19712
    v_exp_f32 v42, v18
    v_exp_f32 v43, v19
    v_add_u32 v144, s70, v144
    v_add_u32 v140, s70, v140
    s_waitcnt lgkmcnt(1)
    s_barrier
    v_mfma_f32_32x32x16_bf16 v[4:19], v[44:47], v[60:63], 0
    ds_read_b128 v[44:47], v136 offset:25344
    v_exp_f32 v20, v20
    v_exp_f32 v21, v21
    v_smfmac_f32_32x32x32_bf16 v[64:79], v[56:59], v[36:43], v167
    ds_read_b128 v[56:59], v139 offset:19712
    v_exp_f32_e64 v22, v22
    v_mfma_f32_32x32x8_bf16 v[4:19], v[48:49], v[50:51], v[4:19]
    ds_read_b64 v[48:49], v137 offset:25344
    v_exp_f32 v23, v23
    v_exp_f32 v24, v24
    v_mfma_f32_32x32x16_bf16 v[80:95], v[124:127], v[128:131], v[80:95]
    ds_read_b128 v[128:131], v142 offset:0
    v_exp_f32 v25, v25
    v_exp_f32 v26, v26
    v_mfma_f32_32x32x16_bf16 v[96:111], v[112:115], v[120:123], v[96:111]
    ds_read_b128 v[120:123], v141 offset:4096
    v_exp_f32 v27, v27
    v_exp_f32 v36, v28
    v_exp_f32_e64 v37, v29
    v_mfma_f32_32x32x16_bf16 v[96:111], v[124:127], v[132:135], v[96:111]
    ds_read_b128 v[132:135], v142 offset:4096
    ds_read_b64_tr_b16 v[124:125], v140 offset:2560
    ds_read_b64_tr_b16 v[126:127], v140 offset:3200
    v_exp_f32_e64 v38, v30
    v_mfma_f32_32x32x16_bf16 v[80:95], v[112:115], v[116:119], v[80:95]
    ds_read_b128 v[116:119], v141 offset:0
    ds_read_b64_tr_b16 v[112:113], v140 offset:0
    ds_read_b64_tr_b16 v[114:115], v140 offset:640
    v_exp_f32 v39, v31
    v_exp_f32 v40, v32
    s_waitcnt lgkmcnt(11)
    v_exp_f32 v41, v33
    v_smfmac_f32_32x32x32_bf16 v[64:79], v[52:55], v[20:27], v167
    ds_read_b128 v[52:55], v138 offset:22528
    v_exp_f32 v42, v34
    v_exp_f32 v43, v35
    v_add_u32 v141, s70, v141
    v_add_u32 v142, s70, v142
    s_waitcnt lgkmcnt(11)
    s_nop 0
    v_mfma_f32_32x32x16_bf16 v[20:35], v[44:47], v[60:63], 0
    ds_read_b128 v[44:47], v136 offset:28160
    v_exp_f32 v4, v4
    s_waitcnt lgkmcnt(11)
    v_exp_f32_e64 v5, v5
    v_smfmac_f32_32x32x32_bf16 v[64:79], v[56:59], v[36:43], v167
    ds_read_b128 v[56:59], v139 offset:22528
    s_waitcnt lgkmcnt(11)
    v_exp_f32 v6, v6
    v_mfma_f32_32x32x8_bf16 v[20:35], v[48:49], v[50:51], v[20:35]
    ds_read_b64 v[48:49], v137 offset:28160
    v_exp_f32 v7, v7
    s_waitcnt lgkmcnt(7)
    v_exp_f32_e64 v8, v8
    v_mfma_f32_32x32x16_bf16 v[80:95], v[124:127], v[128:131], v[80:95]
    ds_read_b128 v[128:131], v144 offset:0
    v_exp_f32 v9, v9
    s_waitcnt lgkmcnt(5)
    v_exp_f32_e64 v10, v10
    v_mfma_f32_32x32x16_bf16 v[96:111], v[112:115], v[120:123], v[96:111]
    ds_read_b128 v[120:123], v143 offset:4096
    v_exp_f32 v11, v11
    v_exp_f32 v36, v12
    v_exp_f32_e64 v37, v13
    v_mfma_f32_32x32x16_bf16 v[96:111], v[124:127], v[132:135], v[96:111]
    ds_read_b128 v[132:135], v144 offset:4096
    ds_read_b64_tr_b16 v[124:125], v140 offset:7680
    ds_read_b64_tr_b16 v[126:127], v140 offset:8320
    v_exp_f32_e64 v38, v14
    v_mfma_f32_32x32x16_bf16 v[80:95], v[112:115], v[116:119], v[80:95]
    ds_read_b128 v[116:119], v143 offset:0
    ds_read_b64_tr_b16 v[112:113], v140 offset:5120
    ds_read_b64_tr_b16 v[114:115], v140 offset:5760
    v_exp_f32 v39, v15
    v_exp_f32 v40, v16
    s_waitcnt lgkmcnt(11)
    v_exp_f32 v41, v17
    v_smfmac_f32_32x32x32_bf16 v[64:79], v[52:55], v[4:11], v167
    ds_read_b128 v[52:55], v138 offset:25344
    v_exp_f32 v42, v18
    v_exp_f32 v43, v19
    v_add_u32 v143, s70, v143
    v_add_u32 v144, s70, v144
    v_add_u32 v140, s70, v140
    s_waitcnt lgkmcnt(1)
    s_barrier
    s_nop 0
    v_mfma_f32_32x32x16_bf16 v[4:19], v[44:47], v[60:63], 0
    ds_read_b128 v[44:47], v136 offset:30976
    v_exp_f32 v20, v20
    v_exp_f32 v21, v21
    v_smfmac_f32_32x32x32_bf16 v[64:79], v[56:59], v[36:43], v167
    ds_read_b128 v[56:59], v139 offset:25344
    v_exp_f32_e64 v22, v22
    v_mfma_f32_32x32x8_bf16 v[4:19], v[48:49], v[50:51], v[4:19]
    ds_read_b64 v[48:49], v137 offset:30976
    v_exp_f32 v23, v23
    v_exp_f32 v24, v24
    v_mfma_f32_32x32x16_bf16 v[80:95], v[124:127], v[128:131], v[80:95]
    ds_read_b128 v[128:131], v142 offset:0
    v_exp_f32 v25, v25
    v_exp_f32 v26, v26
    v_mfma_f32_32x32x16_bf16 v[96:111], v[112:115], v[120:123], v[96:111]
    ds_read_b128 v[120:123], v141 offset:4096
    v_exp_f32 v27, v27
    v_exp_f32 v36, v28
    v_exp_f32_e64 v37, v29
    v_mfma_f32_32x32x16_bf16 v[96:111], v[124:127], v[132:135], v[96:111]
    ds_read_b128 v[132:135], v142 offset:4096
    ds_read_b64_tr_b16 v[124:125], v140 offset:2560
    ds_read_b64_tr_b16 v[126:127], v140 offset:3200
    v_exp_f32_e64 v38, v30
    v_mfma_f32_32x32x16_bf16 v[80:95], v[112:115], v[116:119], v[80:95]
    ds_read_b128 v[116:119], v141 offset:0
    ds_read_b64_tr_b16 v[112:113], v140 offset:0
    ds_read_b64_tr_b16 v[114:115], v140 offset:640
    v_exp_f32 v39, v31
    v_exp_f32 v40, v32
    s_waitcnt lgkmcnt(11)
    v_exp_f32 v41, v33
    v_smfmac_f32_32x32x32_bf16 v[64:79], v[52:55], v[20:27], v167
    ds_read_b128 v[52:55], v138 offset:28160
    v_exp_f32 v42, v34
    v_exp_f32 v43, v35
    v_add_u32 v141, s74, v141
    v_add_u32 v142, s74, v142
    s_waitcnt lgkmcnt(11)
    s_nop 0
    v_mfma_f32_32x32x16_bf16 v[20:35], v[44:47], v[60:63], 0
    ds_read_b128 v[44:47], v136 offset:33792
    v_exp_f32 v4, v4
    s_waitcnt lgkmcnt(11)
    v_exp_f32_e64 v5, v5
    v_smfmac_f32_32x32x32_bf16 v[64:79], v[56:59], v[36:43], v167
    ds_read_b128 v[56:59], v139 offset:28160
    s_waitcnt lgkmcnt(11)
    v_exp_f32 v6, v6
    v_mfma_f32_32x32x8_bf16 v[20:35], v[48:49], v[50:51], v[20:35]
    ds_read_b64 v[48:49], v137 offset:33792
    v_exp_f32 v7, v7
    s_waitcnt lgkmcnt(7)
    v_exp_f32_e64 v8, v8
    v_mfma_f32_32x32x16_bf16 v[80:95], v[124:127], v[128:131], v[80:95]
    ds_read_b128 v[128:131], v144 offset:0
    v_exp_f32 v9, v9
    s_waitcnt lgkmcnt(5)
    v_exp_f32_e64 v10, v10
    v_mfma_f32_32x32x16_bf16 v[96:111], v[112:115], v[120:123], v[96:111]
    ds_read_b128 v[120:123], v143 offset:4096
    v_exp_f32 v11, v11
    v_exp_f32 v36, v12
    v_exp_f32_e64 v37, v13
    v_mfma_f32_32x32x16_bf16 v[96:111], v[124:127], v[132:135], v[96:111]
    ds_read_b128 v[132:135], v144 offset:4096
    ds_read_b64_tr_b16 v[124:125], v140 offset:7680
    ds_read_b64_tr_b16 v[126:127], v140 offset:8320
    v_exp_f32_e64 v38, v14
    v_mfma_f32_32x32x16_bf16 v[80:95], v[112:115], v[116:119], v[80:95]
    ds_read_b128 v[116:119], v143 offset:0
    ds_read_b64_tr_b16 v[112:113], v140 offset:5120
    ds_read_b64_tr_b16 v[114:115], v140 offset:5760
    v_exp_f32 v39, v15
    v_exp_f32 v40, v16
    s_waitcnt lgkmcnt(11)
    v_exp_f32 v41, v17
    v_smfmac_f32_32x32x32_bf16 v[64:79], v[52:55], v[4:11], v167
    ds_read_b128 v[52:55], v138 offset:30976
    v_exp_f32 v42, v18
    v_exp_f32 v43, v19
    v_add_u32 v143, s74, v143
    v_add_u32 v144, s74, v144
    v_add_u32 v140, s74, v140
    s_waitcnt lgkmcnt(1)
    s_barrier
    s_nop 0
    v_mfma_f32_32x32x16_bf16 v[4:19], v[44:47], v[60:63], 0
    ds_read_b128 v[44:47], v136 offset:36608
    v_exp_f32 v20, v20
    v_exp_f32 v21, v21
    v_smfmac_f32_32x32x32_bf16 v[64:79], v[56:59], v[36:43], v167
    ds_read_b128 v[56:59], v139 offset:30976
    v_exp_f32_e64 v22, v22
    v_mfma_f32_32x32x8_bf16 v[4:19], v[48:49], v[50:51], v[4:19]
    ds_read_b64 v[48:49], v137 offset:36608
    v_exp_f32 v23, v23
    v_exp_f32 v24, v24
    v_mfma_f32_32x32x16_bf16 v[80:95], v[124:127], v[128:131], v[80:95]
    ds_read_b128 v[128:131], v142 offset:0
    v_exp_f32 v25, v25
    v_exp_f32 v26, v26
    v_mfma_f32_32x32x16_bf16 v[96:111], v[112:115], v[120:123], v[96:111]
    ds_read_b128 v[120:123], v141 offset:4096
    v_exp_f32 v27, v27
    v_exp_f32 v36, v28
    v_exp_f32_e64 v37, v29
    v_mfma_f32_32x32x16_bf16 v[96:111], v[124:127], v[132:135], v[96:111]
    ds_read_b128 v[132:135], v142 offset:4096
    ds_read_b64_tr_b16 v[124:125], v140 offset:2560
    ds_read_b64_tr_b16 v[126:127], v140 offset:3200
    v_exp_f32_e64 v38, v30
    v_mfma_f32_32x32x16_bf16 v[80:95], v[112:115], v[116:119], v[80:95]
    ds_read_b128 v[116:119], v141 offset:0
    ds_read_b64_tr_b16 v[112:113], v140 offset:0
    ds_read_b64_tr_b16 v[114:115], v140 offset:640
    v_exp_f32 v39, v31
    v_exp_f32 v40, v32
    s_waitcnt lgkmcnt(11)
    v_exp_f32 v41, v33
    v_smfmac_f32_32x32x32_bf16 v[64:79], v[52:55], v[20:27], v167
    ds_read_b128 v[52:55], v138 offset:33792
    v_exp_f32 v42, v34
    v_exp_f32 v43, v35
    v_add_u32 v141, s70, v141
    v_add_u32 v142, s70, v142
    s_waitcnt lgkmcnt(11)
    s_nop 0
    v_mfma_f32_32x32x16_bf16 v[20:35], v[44:47], v[60:63], 0
    ds_read_b128 v[44:47], v136 offset:39424
    v_exp_f32 v4, v4
    s_waitcnt lgkmcnt(11)
    v_exp_f32_e64 v5, v5
    v_smfmac_f32_32x32x32_bf16 v[64:79], v[56:59], v[36:43], v167
    ds_read_b128 v[56:59], v139 offset:33792
    s_waitcnt lgkmcnt(11)
    v_exp_f32 v6, v6
    v_mfma_f32_32x32x8_bf16 v[20:35], v[48:49], v[50:51], v[20:35]
    ds_read_b64 v[48:49], v137 offset:39424
    v_exp_f32 v7, v7
    s_waitcnt lgkmcnt(7)
    v_exp_f32_e64 v8, v8
    v_mfma_f32_32x32x16_bf16 v[80:95], v[124:127], v[128:131], v[80:95]
    ds_read_b128 v[128:131], v144 offset:0
    v_exp_f32 v9, v9
    s_waitcnt lgkmcnt(5)
    v_exp_f32_e64 v10, v10
    v_mfma_f32_32x32x16_bf16 v[96:111], v[112:115], v[120:123], v[96:111]
    ds_read_b128 v[120:123], v143 offset:4096
    v_exp_f32 v11, v11
    v_exp_f32 v36, v12
    v_exp_f32_e64 v37, v13
    v_mfma_f32_32x32x16_bf16 v[96:111], v[124:127], v[132:135], v[96:111]
    ds_read_b128 v[132:135], v144 offset:4096
    ds_read_b64_tr_b16 v[124:125], v140 offset:7680
    ds_read_b64_tr_b16 v[126:127], v140 offset:8320
    v_exp_f32_e64 v38, v14
    v_mfma_f32_32x32x16_bf16 v[80:95], v[112:115], v[116:119], v[80:95]
    ds_read_b128 v[116:119], v143 offset:0
    ds_read_b64_tr_b16 v[112:113], v140 offset:5120
    ds_read_b64_tr_b16 v[114:115], v140 offset:5760
    v_exp_f32 v39, v15
    v_exp_f32 v40, v16
    s_waitcnt lgkmcnt(11)
    v_exp_f32 v41, v17
    v_smfmac_f32_32x32x32_bf16 v[64:79], v[52:55], v[4:11], v167
    ds_read_b128 v[52:55], v138 offset:36608
    v_exp_f32 v42, v18
    v_exp_f32 v43, v19
    v_add_u32 v143, s70, v143
    v_add_u32 v144, s70, v144
    v_add_u32 v140, s70, v140
    s_waitcnt lgkmcnt(1)
    s_barrier
    s_nop 0
    v_mfma_f32_32x32x16_bf16 v[4:19], v[44:47], v[60:63], 0
    ds_read_b128 v[44:47], v136 offset:42240
    v_exp_f32 v20, v20
    v_exp_f32 v21, v21
    v_smfmac_f32_32x32x32_bf16 v[64:79], v[56:59], v[36:43], v167
    ds_read_b128 v[56:59], v139 offset:36608
    v_exp_f32_e64 v22, v22
    v_mfma_f32_32x32x8_bf16 v[4:19], v[48:49], v[50:51], v[4:19]
    ds_read_b64 v[48:49], v137 offset:42240
    v_exp_f32 v23, v23
    v_exp_f32 v24, v24
    v_mfma_f32_32x32x16_bf16 v[80:95], v[124:127], v[128:131], v[80:95]
    ds_read_b128 v[128:131], v142 offset:0
    v_exp_f32 v25, v25
    v_exp_f32 v26, v26
    v_mfma_f32_32x32x16_bf16 v[96:111], v[112:115], v[120:123], v[96:111]
    ds_read_b128 v[120:123], v141 offset:4096
    v_exp_f32 v27, v27
    v_exp_f32 v36, v28
    v_exp_f32_e64 v37, v29
    v_mfma_f32_32x32x16_bf16 v[96:111], v[124:127], v[132:135], v[96:111]
    ds_read_b128 v[132:135], v142 offset:4096
    ds_read_b64_tr_b16 v[124:125], v140 offset:2560
    ds_read_b64_tr_b16 v[126:127], v140 offset:3200
    v_exp_f32_e64 v38, v30
    v_mfma_f32_32x32x16_bf16 v[80:95], v[112:115], v[116:119], v[80:95]
    ds_read_b128 v[116:119], v141 offset:0
    ds_read_b64_tr_b16 v[112:113], v140 offset:0
    ds_read_b64_tr_b16 v[114:115], v140 offset:640
    v_exp_f32 v39, v31
    v_exp_f32 v40, v32
    s_waitcnt lgkmcnt(11)
    v_exp_f32 v41, v33
    v_smfmac_f32_32x32x32_bf16 v[64:79], v[52:55], v[20:27], v167
    ds_read_b128 v[52:55], v138 offset:39424
    v_exp_f32 v42, v34
    v_exp_f32 v43, v35
    v_add_u32 v141, s70, v141
    v_add_u32 v142, s70, v142
    s_waitcnt lgkmcnt(11)
    s_nop 0
    v_mfma_f32_32x32x16_bf16 v[20:35], v[44:47], v[60:63], 0
    ds_read_b128 v[44:47], v136 offset:0
    v_exp_f32 v4, v4
    s_waitcnt lgkmcnt(11)
    v_exp_f32_e64 v5, v5
    v_smfmac_f32_32x32x32_bf16 v[64:79], v[56:59], v[36:43], v167
    ds_read_b128 v[56:59], v139 offset:39424
    s_waitcnt lgkmcnt(11)
    v_exp_f32 v6, v6
    v_mfma_f32_32x32x8_bf16 v[20:35], v[48:49], v[50:51], v[20:35]
    ds_read_b64 v[48:49], v137 offset:0
    v_exp_f32 v7, v7
    s_waitcnt lgkmcnt(7)
    v_exp_f32_e64 v8, v8
    v_mfma_f32_32x32x16_bf16 v[80:95], v[124:127], v[128:131], v[80:95]
    ds_read_b128 v[128:131], v144 offset:0
    v_exp_f32 v9, v9
    s_waitcnt lgkmcnt(5)
    v_exp_f32_e64 v10, v10
    v_mfma_f32_32x32x16_bf16 v[96:111], v[112:115], v[120:123], v[96:111]
    ds_read_b128 v[120:123], v143 offset:4096
    v_exp_f32 v11, v11
    v_exp_f32 v36, v12
    v_exp_f32_e64 v37, v13
    v_mfma_f32_32x32x16_bf16 v[96:111], v[124:127], v[132:135], v[96:111]
    ds_read_b128 v[132:135], v144 offset:4096
    ds_read_b64_tr_b16 v[124:125], v140 offset:7680
    ds_read_b64_tr_b16 v[126:127], v140 offset:8320
    v_exp_f32_e64 v38, v14
    v_mfma_f32_32x32x16_bf16 v[80:95], v[112:115], v[116:119], v[80:95]
    ds_read_b128 v[116:119], v143 offset:0
    ds_read_b64_tr_b16 v[112:113], v140 offset:5120
    ds_read_b64_tr_b16 v[114:115], v140 offset:5760
    v_exp_f32 v39, v15
    v_exp_f32 v40, v16
    s_waitcnt lgkmcnt(11)
    v_exp_f32 v41, v17
    v_smfmac_f32_32x32x32_bf16 v[64:79], v[52:55], v[4:11], v167
    ds_read_b128 v[52:55], v138 offset:42240
    v_exp_f32 v42, v18
    v_exp_f32 v43, v19
    v_add_u32 v143, s70, v143
    v_add_u32 v144, s70, v144
    v_add_u32 v140, s70, v140
    s_waitcnt lgkmcnt(1)
    s_barrier
    s_nop 0
    v_mfma_f32_32x32x16_bf16 v[4:19], v[44:47], v[60:63], 0
    ds_read_b128 v[44:47], v136 offset:2816
    v_exp_f32 v20, v20
    v_exp_f32 v21, v21
    v_smfmac_f32_32x32x32_bf16 v[64:79], v[56:59], v[36:43], v167
    ds_read_b128 v[56:59], v139 offset:42240
    v_exp_f32_e64 v22, v22
    v_mfma_f32_32x32x8_bf16 v[4:19], v[48:49], v[50:51], v[4:19]
    ds_read_b64 v[48:49], v137 offset:2816
    v_exp_f32 v23, v23
    v_exp_f32 v24, v24
    v_mfma_f32_32x32x16_bf16 v[80:95], v[124:127], v[128:131], v[80:95]
    ds_read_b128 v[128:131], v142 offset:0
    v_exp_f32 v25, v25
    v_exp_f32 v26, v26
    v_mfma_f32_32x32x16_bf16 v[96:111], v[112:115], v[120:123], v[96:111]
    ds_read_b128 v[120:123], v141 offset:4096
    v_exp_f32 v27, v27
    v_exp_f32 v36, v28
    v_exp_f32_e64 v37, v29
    v_mfma_f32_32x32x16_bf16 v[96:111], v[124:127], v[132:135], v[96:111]
    ds_read_b128 v[132:135], v142 offset:4096
    ds_read_b64_tr_b16 v[124:125], v140 offset:2560
    ds_read_b64_tr_b16 v[126:127], v140 offset:3200
    v_exp_f32_e64 v38, v30
    v_mfma_f32_32x32x16_bf16 v[80:95], v[112:115], v[116:119], v[80:95]
    ds_read_b128 v[116:119], v141 offset:0
    ds_read_b64_tr_b16 v[112:113], v140 offset:0
    ds_read_b64_tr_b16 v[114:115], v140 offset:640
    v_exp_f32 v39, v31
    v_exp_f32 v40, v32
    s_waitcnt lgkmcnt(11)
    v_exp_f32 v41, v33
    v_smfmac_f32_32x32x32_bf16 v[64:79], v[52:55], v[20:27], v167
    ds_read_b128 v[52:55], v138 offset:0
    v_exp_f32 v42, v34
    v_exp_f32 v43, v35
    v_add_u32 v141, s74, v141
    v_add_u32 v142, s74, v142
    s_waitcnt lgkmcnt(11)
    s_nop 0
    v_mfma_f32_32x32x16_bf16 v[20:35], v[44:47], v[60:63], 0
    ds_read_b128 v[44:47], v136 offset:5632
    v_exp_f32 v4, v4
    s_waitcnt lgkmcnt(11)
    v_exp_f32_e64 v5, v5
    v_smfmac_f32_32x32x32_bf16 v[64:79], v[56:59], v[36:43], v167
    ds_read_b128 v[56:59], v139 offset:0
    s_waitcnt lgkmcnt(11)
    v_exp_f32 v6, v6
    v_mfma_f32_32x32x8_bf16 v[20:35], v[48:49], v[50:51], v[20:35]
    ds_read_b64 v[48:49], v137 offset:5632
    v_exp_f32 v7, v7
    s_waitcnt lgkmcnt(7)
    v_exp_f32_e64 v8, v8
    v_mfma_f32_32x32x16_bf16 v[80:95], v[124:127], v[128:131], v[80:95]
    ds_read_b128 v[128:131], v144 offset:0
    v_exp_f32 v9, v9
    s_waitcnt lgkmcnt(5)
    v_exp_f32_e64 v10, v10
    v_mfma_f32_32x32x16_bf16 v[96:111], v[112:115], v[120:123], v[96:111]
    ds_read_b128 v[120:123], v143 offset:4096
    v_exp_f32 v11, v11
    v_exp_f32 v36, v12
    v_exp_f32_e64 v37, v13
    v_mfma_f32_32x32x16_bf16 v[96:111], v[124:127], v[132:135], v[96:111]
    ds_read_b128 v[132:135], v144 offset:4096
    ds_read_b64_tr_b16 v[124:125], v140 offset:7680
    ds_read_b64_tr_b16 v[126:127], v140 offset:8320
    v_exp_f32_e64 v38, v14
    v_mfma_f32_32x32x16_bf16 v[80:95], v[112:115], v[116:119], v[80:95]
    ds_read_b128 v[116:119], v143 offset:0
    ds_read_b64_tr_b16 v[112:113], v140 offset:5120
    ds_read_b64_tr_b16 v[114:115], v140 offset:5760
    v_exp_f32 v39, v15
    v_exp_f32 v40, v16
    s_waitcnt lgkmcnt(11)
    v_exp_f32 v41, v17
    v_smfmac_f32_32x32x32_bf16 v[64:79], v[52:55], v[4:11], v167
    ds_read_b128 v[52:55], v138 offset:2816
    v_exp_f32 v42, v18
    v_exp_f32 v43, v19
    v_add_u32 v143, s74, v143
    v_add_u32 v144, s74, v144
    v_add_u32 v140, s74, v140
    s_waitcnt lgkmcnt(1)
    s_barrier
    s_nop 0
    v_mfma_f32_32x32x16_bf16 v[4:19], v[44:47], v[60:63], 0
    ds_read_b128 v[44:47], v136 offset:8448
    v_exp_f32 v20, v20
    v_exp_f32 v21, v21
    v_smfmac_f32_32x32x32_bf16 v[64:79], v[56:59], v[36:43], v167
    ds_read_b128 v[56:59], v139 offset:2816
    v_exp_f32_e64 v22, v22
    v_mfma_f32_32x32x8_bf16 v[4:19], v[48:49], v[50:51], v[4:19]
    ds_read_b64 v[48:49], v137 offset:8448
    v_exp_f32 v23, v23
    v_exp_f32 v24, v24
    v_mfma_f32_32x32x16_bf16 v[80:95], v[124:127], v[128:131], v[80:95]
    ds_read_b128 v[128:131], v142 offset:0
    v_exp_f32 v25, v25
    v_exp_f32 v26, v26
    v_mfma_f32_32x32x16_bf16 v[96:111], v[112:115], v[120:123], v[96:111]
    ds_read_b128 v[120:123], v141 offset:4096
    v_exp_f32 v27, v27
    v_exp_f32 v36, v28
    v_exp_f32_e64 v37, v29
    v_mfma_f32_32x32x16_bf16 v[96:111], v[124:127], v[132:135], v[96:111]
    ds_read_b128 v[132:135], v142 offset:4096
    ds_read_b64_tr_b16 v[124:125], v140 offset:2560
    ds_read_b64_tr_b16 v[126:127], v140 offset:3200
    v_exp_f32_e64 v38, v30
    v_mfma_f32_32x32x16_bf16 v[80:95], v[112:115], v[116:119], v[80:95]
    ds_read_b128 v[116:119], v141 offset:0
    ds_read_b64_tr_b16 v[112:113], v140 offset:0
    ds_read_b64_tr_b16 v[114:115], v140 offset:640
    v_exp_f32 v39, v31
    v_exp_f32 v40, v32
    s_waitcnt lgkmcnt(11)
    v_exp_f32 v41, v33
    v_smfmac_f32_32x32x32_bf16 v[64:79], v[52:55], v[20:27], v167
    ds_read_b128 v[52:55], v138 offset:5632
    v_exp_f32 v42, v34
    s_waitcnt lgkmcnt(11)
    v_exp_f32_e64 v43, v35
    v_mfma_f32_32x32x16_bf16 v[20:35], v[44:47], v[60:63], 0
    ds_read_b128 v[44:47], v136 offset:11264
    v_exp_f32 v4, v4
    s_waitcnt lgkmcnt(11)
    v_exp_f32_e64 v5, v5
    v_smfmac_f32_32x32x32_bf16 v[64:79], v[56:59], v[36:43], v167
    ds_read_b128 v[56:59], v139 offset:5632
    s_waitcnt lgkmcnt(11)
    v_exp_f32 v6, v6
    v_mfma_f32_32x32x8_bf16 v[20:35], v[48:49], v[50:51], v[20:35]
    ds_read_b64 v[48:49], v137 offset:11264
    v_exp_f32 v7, v7
    s_waitcnt lgkmcnt(7)
    v_exp_f32_e64 v8, v8
    v_mfma_f32_32x32x16_bf16 v[80:95], v[124:127], v[128:131], v[80:95]
    ds_read_b128 v[128:131], v144 offset:0
    v_exp_f32 v9, v9
    s_waitcnt lgkmcnt(5)
    v_exp_f32_e64 v10, v10
    v_mfma_f32_32x32x16_bf16 v[96:111], v[112:115], v[120:123], v[96:111]
    ds_read_b128 v[120:123], v143 offset:4096
    v_exp_f32 v11, v11
    v_exp_f32 v36, v12
    v_exp_f32_e64 v37, v13
    v_mfma_f32_32x32x16_bf16 v[96:111], v[124:127], v[132:135], v[96:111]
    ds_read_b128 v[132:135], v144 offset:4096
    ds_read_b64_tr_b16 v[124:125], v140 offset:7680
    ds_read_b64_tr_b16 v[126:127], v140 offset:8320
    v_exp_f32_e64 v38, v14
    v_mfma_f32_32x32x16_bf16 v[80:95], v[112:115], v[116:119], v[80:95]
    ds_read_b128 v[116:119], v143 offset:0
    ds_read_b64_tr_b16 v[112:113], v140 offset:5120
    ds_read_b64_tr_b16 v[114:115], v140 offset:5760
    v_exp_f32 v39, v15
    v_exp_f32 v40, v16
    s_waitcnt lgkmcnt(11)
    v_exp_f32 v41, v17
    v_smfmac_f32_32x32x32_bf16 v[64:79], v[52:55], v[4:11], v167
    ds_read_b128 v[52:55], v138 offset:8448
    v_exp_f32 v42, v18
    s_waitcnt lgkmcnt(11)
    v_exp_f32_e64 v43, v19
    v_mfma_f32_32x32x16_bf16 v[4:19], v[44:47], v[60:63], 0
    ds_read_b128 v[44:47], v136 offset:14080
    v_exp_f32 v20, v20
    s_waitcnt lgkmcnt(11)
    v_exp_f32_e64 v21, v21
    v_smfmac_f32_32x32x32_bf16 v[64:79], v[56:59], v[36:43], v167
    ds_read_b128 v[56:59], v139 offset:8448
    s_waitcnt lgkmcnt(11)
    v_exp_f32 v22, v22
    v_mfma_f32_32x32x8_bf16 v[4:19], v[48:49], v[50:51], v[4:19]
    ds_read_b64 v[48:49], v137 offset:14080
    v_exp_f32 v23, v23
    s_waitcnt lgkmcnt(7)
    v_exp_f32_e64 v24, v24
    v_mfma_f32_32x32x16_bf16 v[80:95], v[124:127], v[128:131], v[80:95]
    v_exp_f32 v25, v25
    s_waitcnt lgkmcnt(4)
    v_exp_f32_e64 v26, v26
    v_mfma_f32_32x32x16_bf16 v[96:111], v[112:115], v[120:123], v[96:111]
    v_exp_f32 v27, v27
    v_exp_f32 v36, v28
    v_exp_f32_e64 v37, v29
    v_mfma_f32_32x32x16_bf16 v[96:111], v[124:127], v[132:135], v[96:111]
    v_exp_f32_e64 v38, v30
    v_mfma_f32_32x32x16_bf16 v[80:95], v[112:115], v[116:119], v[80:95]
    v_exp_f32 v39, v31
    v_exp_f32 v40, v32
    s_waitcnt lgkmcnt(3)
    v_exp_f32 v41, v33
    v_smfmac_f32_32x32x32_bf16 v[64:79], v[52:55], v[20:27], v167
    ds_read_b128 v[52:55], v138 offset:11264
    v_exp_f32 v42, v34
    v_exp_f32 v43, v35
    s_mov_b32 s8, 0x3fb8aa3b
    s_mov_b32 s9, 0x358637bd
    s_nop 3
    v_pk_mul_f32 v[112:113], v[80:81], s[8:9] op_sel_hi:[1,0]
    v_pk_mul_f32 v[114:115], v[82:83], s[8:9] op_sel_hi:[1,0]
    v_exp_f32_e64 v112, v112 clamp
    v_exp_f32_e64 v113, v113 clamp
    v_exp_f32_e64 v114, v114 clamp
    v_exp_f32_e64 v115, v115 clamp
    v_max_f32 v80, s9, v80
    v_max_f32 v81, s9, v81
    v_max_f32 v82, s9, v82
    v_max_f32 v83, s9, v83
    v_pk_add_f32 v[80:81], v[80:81], v[112:113]
    v_pk_add_f32 v[82:83], v[82:83], v[114:115]
    v_cvt_pk_bf16_f32 v80, v80, v81
    v_cvt_pk_bf16_f32 v81, v82, v83
    ds_write_b64 v162, v[80:81] offset:0
    v_pk_mul_f32 v[112:113], v[84:85], s[8:9] op_sel_hi:[1,0]
    v_pk_mul_f32 v[114:115], v[86:87], s[8:9] op_sel_hi:[1,0]
    v_exp_f32_e64 v112, v112 clamp
    v_exp_f32_e64 v113, v113 clamp
    v_exp_f32_e64 v114, v114 clamp
    v_exp_f32_e64 v115, v115 clamp
    v_max_f32 v84, s9, v84
    v_max_f32 v85, s9, v85
    v_max_f32 v86, s9, v86
    v_max_f32 v87, s9, v87
    v_pk_add_f32 v[84:85], v[84:85], v[112:113]
    v_pk_add_f32 v[86:87], v[86:87], v[114:115]
    v_cvt_pk_bf16_f32 v84, v84, v85
    v_cvt_pk_bf16_f32 v85, v86, v87
    ds_write_b64 v163, v[84:85] offset:0
    v_pk_mul_f32 v[112:113], v[96:97], s[8:9] op_sel_hi:[1,0]
    v_pk_mul_f32 v[114:115], v[98:99], s[8:9] op_sel_hi:[1,0]
    v_exp_f32_e64 v112, v112 clamp
    v_exp_f32_e64 v113, v113 clamp
    v_exp_f32_e64 v114, v114 clamp
    v_exp_f32_e64 v115, v115 clamp
    v_max_f32 v96, s9, v96
    v_max_f32 v97, s9, v97
    v_max_f32 v98, s9, v98
    v_max_f32 v99, s9, v99
    v_pk_add_f32 v[96:97], v[96:97], v[112:113]
    v_pk_add_f32 v[98:99], v[98:99], v[114:115]
    v_cvt_pk_bf16_f32 v96, v96, v97
    v_cvt_pk_bf16_f32 v97, v98, v99
    ds_write_b64 v162, v[96:97] offset:5120
    v_pk_mul_f32 v[112:113], v[100:101], s[8:9] op_sel_hi:[1,0]
    v_pk_mul_f32 v[114:115], v[102:103], s[8:9] op_sel_hi:[1,0]
    v_exp_f32_e64 v112, v112 clamp
    v_exp_f32_e64 v113, v113 clamp
    v_exp_f32_e64 v114, v114 clamp
    v_exp_f32_e64 v115, v115 clamp
    v_max_f32 v100, s9, v100
    v_max_f32 v101, s9, v101
    v_max_f32 v102, s9, v102
    v_max_f32 v103, s9, v103
    v_pk_add_f32 v[100:101], v[100:101], v[112:113]
    v_pk_add_f32 v[102:103], v[102:103], v[114:115]
    v_cvt_pk_bf16_f32 v100, v100, v101
    v_cvt_pk_bf16_f32 v101, v102, v103
    ds_write_b64 v163, v[100:101] offset:5120
    s_cmp_eq_u32 s3, 2
    s_cbranch_scc1 B_jobs
    v_pk_mul_f32 v[112:113], v[88:89], s[8:9] op_sel_hi:[1,0]
    v_pk_mul_f32 v[114:115], v[90:91], s[8:9] op_sel_hi:[1,0]
    v_exp_f32_e64 v112, v112 clamp
    v_exp_f32_e64 v113, v113 clamp
    v_exp_f32_e64 v114, v114 clamp
    v_exp_f32_e64 v115, v115 clamp
    v_max_f32 v88, s9, v88
    v_max_f32 v89, s9, v89
    v_max_f32 v90, s9, v90
    v_max_f32 v91, s9, v91
    v_pk_add_f32 v[88:89], v[88:89], v[112:113]
    v_pk_add_f32 v[90:91], v[90:91], v[114:115]
    v_cvt_pk_bf16_f32 v88, v88, v89
    v_cvt_pk_bf16_f32 v89, v90, v91
    ds_write_b64 v165, v[88:89] offset:0
    v_pk_mul_f32 v[112:113], v[92:93], s[8:9] op_sel_hi:[1,0]
    v_pk_mul_f32 v[114:115], v[94:95], s[8:9] op_sel_hi:[1,0]
    v_exp_f32_e64 v112, v112 clamp
    v_exp_f32_e64 v113, v113 clamp
    v_exp_f32_e64 v114, v114 clamp
    v_exp_f32_e64 v115, v115 clamp
    v_max_f32 v92, s9, v92
    v_max_f32 v93, s9, v93
    v_max_f32 v94, s9, v94
    v_max_f32 v95, s9, v95
    v_pk_add_f32 v[92:93], v[92:93], v[112:113]
    v_pk_add_f32 v[94:95], v[94:95], v[114:115]
    v_cvt_pk_bf16_f32 v92, v92, v93
    v_cvt_pk_bf16_f32 v93, v94, v95
    ds_write_b64 v166, v[92:93] offset:0
    v_pk_mul_f32 v[112:113], v[104:105], s[8:9] op_sel_hi:[1,0]
    v_pk_mul_f32 v[114:115], v[106:107], s[8:9] op_sel_hi:[1,0]
    v_exp_f32_e64 v112, v112 clamp
    v_exp_f32_e64 v113, v113 clamp
    v_exp_f32_e64 v114, v114 clamp
    v_exp_f32_e64 v115, v115 clamp
    v_max_f32 v104, s9, v104
    v_max_f32 v105, s9, v105
    v_max_f32 v106, s9, v106
    v_max_f32 v107, s9, v107
    v_pk_add_f32 v[104:105], v[104:105], v[112:113]
    v_pk_add_f32 v[106:107], v[106:107], v[114:115]
    v_cvt_pk_bf16_f32 v104, v104, v105
    v_cvt_pk_bf16_f32 v105, v106, v107
    ds_write_b64 v165, v[104:105] offset:5120
    v_pk_mul_f32 v[112:113], v[108:109], s[8:9] op_sel_hi:[1,0]
    v_pk_mul_f32 v[114:115], v[110:111], s[8:9] op_sel_hi:[1,0]
    v_exp_f32_e64 v112, v112 clamp
    v_exp_f32_e64 v113, v113 clamp
    v_exp_f32_e64 v114, v114 clamp
    v_exp_f32_e64 v115, v115 clamp
    v_max_f32 v108, s9, v108
    v_max_f32 v109, s9, v109
    v_max_f32 v110, s9, v110
    v_max_f32 v111, s9, v111
    v_pk_add_f32 v[108:109], v[108:109], v[112:113]
    v_pk_add_f32 v[110:111], v[110:111], v[114:115]
    v_cvt_pk_bf16_f32 v108, v108, v109
    v_cvt_pk_bf16_f32 v109, v110, v111
    ds_write_b64 v166, v[108:109] offset:5120
    s_branch B_jobs
.p2align 3
FU_C:
    s_waitcnt lgkmcnt(3)
    s_barrier
    v_mfma_f32_32x32x16_bf16 v[20:35], v[44:47], v[60:63], 0
    ds_read_b128 v[44:47], v136 offset:33792
    ds_read_b64_tr_b16 v[112:113], v140 offset:0
    ds_read_b64_tr_b16 v[114:115], v140 offset:1280
    ds_read_b128 v[116:119], v141 offset:0
    ds_read_b128 v[120:123], v141 offset:4096
    v_exp_f32 v4, v4
    v_exp_f32 v5, v5
    v_exp_f32 v6, v6
    s_waitcnt lgkmcnt(7)
    v_exp_f32_e64 v7, v7
    v_mfma_f32_32x32x8_bf16 v[20:35], v[48:49], v[50:51], v[20:35]
    ds_read_b64 v[48:49], v137 offset:33792
    ds_read_b64_tr_b16 v[124:125], v140 offset:5120
    ds_read_b64_tr_b16 v[126:127], v140 offset:6400
    ds_read_b128 v[128:131], v142 offset:0
    ds_read_b128 v[132:135], v142 offset:4096
    v_exp_f32 v8, v8
    v_exp_f32 v9, v9
    v_exp_f32 v10, v10
    s_waitcnt lgkmcnt(11)
    v_exp_f32_e64 v11, v11
    v_smfmac_f32_32x32x32_bf16 v[64:79], v[56:59], v[36:43], v167
    ds_read_b128 v[56:59], v139 offset:28160
    v_exp_f32 v36, v12
    v_exp_f32 v37, v13
    v_exp_f32 v38, v14
    s_waitcnt lgkmcnt(11)
    v_exp_f32_e64 v39, v15
    v_smfmac_f32_32x32x32_bf16 v[64:79], v[52:55], v[4:11], v167
    ds_read_b128 v[52:55], v138 offset:30976
    v_exp_f32 v40, v16
    v_exp_f32 v41, v17
    v_exp_f32 v42, v18
    v_exp_f32 v43, v19
    v_add_u32 v141, s70, v141
    v_add_u32 v142, s70, v142
    s_waitcnt lgkmcnt(11)
    s_nop 0
    v_mfma_f32_32x32x16_bf16 v[4:19], v[44:47], v[60:63], 0
    ds_read_b128 v[44:47], v136 offset:36608
    v_exp_f32 v20, v20
    v_exp_f32 v21, v21
    v_exp_f32 v22, v22
    s_waitcnt lgkmcnt(7)
    v_exp_f32_e64 v23, v23
    v_mfma_f32_32x32x8_bf16 v[4:19], v[48:49], v[50:51], v[4:19]
    ds_read_b64 v[48:49], v137 offset:36608
    v_exp_f32 v24, v24
    v_exp_f32 v25, v25
    v_exp_f32 v26, v26
    s_waitcnt lgkmcnt(3)
    v_exp_f32_e64 v27, v27
    v_smfmac_f32_32x32x32_bf16 v[64:79], v[56:59], v[36:43], v167
    ds_read_b128 v[56:59], v139 offset:30976
    v_exp_f32 v36, v28
    v_exp_f32 v37, v29
    v_exp_f32 v38, v30
    s_waitcnt lgkmcnt(3)
    v_exp_f32_e64 v39, v31
    v_smfmac_f32_32x32x32_bf16 v[64:79], v[52:55], v[20:27], v167
    ds_read_b128 v[52:55], v138 offset:33792
    v_exp_f32 v40, v32
    v_exp_f32 v41, v33
    v_exp_f32 v42, v34
    s_waitcnt lgkmcnt(3)
    v_exp_f32_e64 v43, v35
    v_mfma_f32_32x32x16_bf16 v[20:35], v[44:47], v[60:63], 0
    ds_read_b128 v[44:47], v136 offset:39424
    v_exp_f32 v4, v4
    v_exp_f32 v5, v5
    v_mfma_f32_32x32x16_bf16 v[96:111], v[120:123], v[112:115], 0
    ds_read_b128 v[120:123], v143 offset:4096
    v_exp_f32 v6, v6
    v_exp_f32 v7, v7
    s_waitcnt lgkmcnt(4)
    v_exp_f32 v8, v8
    v_mfma_f32_32x32x8_bf16 v[20:35], v[48:49], v[50:51], v[20:35]
    ds_read_b64 v[48:49], v137 offset:39424
    v_exp_f32 v9, v9
    v_exp_f32 v10, v10
    s_waitcnt lgkmcnt(4)
    v_exp_f32 v11, v11
    v_smfmac_f32_32x32x32_bf16 v[64:79], v[56:59], v[36:43], v167
    ds_read_b128 v[56:59], v139 offset:33792
    v_exp_f32 v36, v12
    v_exp_f32 v37, v13
    v_exp_f32_e64 v38, v14
    v_mfma_f32_32x32x16_bf16 v[80:95], v[116:119], v[112:115], 0
    ds_read_b128 v[116:119], v143 offset:0
    ds_read_b64_tr_b16 v[112:113], v140 offset:10240
    ds_read_b64_tr_b16 v[114:115], v140 offset:11520
    v_exp_f32 v39, v15
    v_exp_f32 v40, v16
    s_waitcnt lgkmcnt(7)
    v_exp_f32 v41, v17
    v_smfmac_f32_32x32x32_bf16 v[64:79], v[52:55], v[4:11], v167
    ds_read_b128 v[52:55], v138 offset:36608
    v_exp_f32 v42, v18
    v_exp_f32 v43, v19
    v_add_u32 v143, s70, v143
    s_waitcnt lgkmcnt(7)
    v_mfma_f32_32x32x16_bf16 v[4:19], v[44:47], v[60:63], 0
    ds_read_b128 v[44:47], v136 offset:42240
    v_exp_f32 v20, v20
    v_exp_f32 v21, v21
    v_mfma_f32_32x32x16_bf16 v[96:111], v[132:135], v[124:127], v[96:111]
    ds_read_b128 v[132:135], v144 offset:4096
    v_exp_f32 v22, v22
    v_exp_f32 v23, v23
    s_waitcnt lgkmcnt(7)
    v_exp_f32 v24, v24
    v_mfma_f32_32x32x8_bf16 v[4:19], v[48:49], v[50:51], v[4:19]
    ds_read_b64 v[48:49], v137 offset:42240
    v_exp_f32 v25, v25
    v_exp_f32 v26, v26
    s_waitcnt lgkmcnt(7)
    v_exp_f32 v27, v27
    v_smfmac_f32_32x32x32_bf16 v[64:79], v[56:59], v[36:43], v167
    ds_read_b128 v[56:59], v139 offset:36608
    v_exp_f32 v36, v28
    v_exp_f32 v37, v29
    v_exp_f32_e64 v38, v30
    v_mfma_f32_32x32x16_bf16 v[80:95], v[128:131], v[124:127], v[80:95]
    ds_read_b128 v[128:131], v144 offset:0
    ds_read_b64_tr_b16 v[124:125], v140 offset:15360
    ds_read_b64_tr_b16 v[126:127], v140 offset:16640
    v_exp_f32 v39, v31
    v_exp_f32 v40, v32
    s_waitcnt lgkmcnt(7)
    v_exp_f32 v41, v33
    v_smfmac_f32_32x32x32_bf16 v[64:79], v[52:55], v[20:27], v167
    ds_read_b128 v[52:55], v138 offset:39424
    v_exp_f32 v42, v34
    v_exp_f32 v43, v35
    v_add_u32 v144, s70, v144
    v_add_u32 v140, s70, v140
    s_waitcnt lgkmcnt(1)
    s_barrier
    v_mfma_f32_32x32x16_bf16 v[20:35], v[44:47], v[60:63], 0
    ds_read_b128 v[44:47], v136 offset:0
    v_exp_f32 v4, v4
    v_exp_f32 v5, v5
    v_smfmac_f32_32x32x32_bf16 v[64:79], v[56:59], v[36:43], v167
    ds_read_b128 v[56:59], v139 offset:39424
    v_exp_f32_e64 v6, v6
    v_mfma_f32_32x32x8_bf16 v[20:35], v[48:49], v[50:51], v[20:35]
    ds_read_b64 v[48:49], v137 offset:0
    v_exp_f32 v7, v7
    v_exp_f32 v8, v8
    v_mfma_f32_32x32x16_bf16 v[80:95], v[128:131], v[124:127], v[80:95]
    ds_read_b128 v[128:131], v142 offset:0
    v_exp_f32 v9, v9
    v_exp_f32 v10, v10
    v_mfma_f32_32x32x16_bf16 v[96:111], v[120:123], v[112:115], v[96:111]
    ds_read_b128 v[120:123], v141 offset:4096
    v_exp_f32 v11, v11
    v_exp_f32 v36, v12
    v_exp_f32_e64 v37, v13
    v_mfma_f32_32x32x16_bf16 v[96:111], v[132:135], v[124:127], v[96:111]
    ds_read_b128 v[132:135], v142 offset:4096
    ds_read_b64_tr_b16 v[124:125], v140 offset:5120
    ds_read_b64_tr_b16 v[126:127], v140 offset:6400
    v_exp_f32_e64 v38, v14
    v_mfma_f32_32x32x16_bf16 v[80:95], v[116:119], v[112:115], v[80:95]
    ds_read_b128 v[116:119], v141 offset:0
    ds_read_b64_tr_b16 v[112:113], v140 offset:0
    ds_read_b64_tr_b16 v[114:115], v140 offset:1280
    v_exp_f32 v39, v15
    v_exp_f32 v40, v16
    s_waitcnt lgkmcnt(11)
    v_exp_f32 v41, v17
    v_smfmac_f32_32x32x32_bf16 v[64:79], v[52:55], v[4:11], v167
    ds_read_b128 v[52:55], v138 offset:42240
    v_exp_f32 v42, v18
    v_exp_f32 v43, v19
    v_add_u32 v141, s70, v141
    v_add_u32 v142, s70, v142
    s_waitcnt lgkmcnt(11)
    s_nop 0
    v_mfma_f32_32x32x16_bf16 v[4:19], v[44:47], v[60:63], 0
    ds_read_b128 v[44:47], v136 offset:2816
    v_exp_f32 v20, v20
    s_waitcnt lgkmcnt(2)
    v_exp_f32_e64 v21, v21
    v_mfma_f32_32x32x16_bf16 v[96:111], v[120:123], v[112:115], v[96:111]
    ds_read_b128 v[120:123], v143 offset:4096
    v_exp_f32 v22, v22
    v_exp_f32 v23, v23
    v_exp_f32_e64 v24, v24
    v_mfma_f32_32x32x8_bf16 v[4:19], v[48:49], v[50:51], v[4:19]
    ds_read_b64 v[48:49], v137 offset:2816
    v_exp_f32 v25, v25
    v_exp_f32 v26, v26
    v_exp_f32_e64 v27, v27
    v_smfmac_f32_32x32x32_bf16 v[64:79], v[56:59], v[36:43], v167
    ds_read_b128 v[56:59], v139 offset:42240
    v_exp_f32 v36, v28
    v_exp_f32 v37, v29
    v_exp_f32_e64 v38, v30
    v_mfma_f32_32x32x16_bf16 v[80:95], v[116:119], v[112:115], v[80:95]
    ds_read_b128 v[116:119], v143 offset:0
    ds_read_b64_tr_b16 v[112:113], v140 offset:10240
    ds_read_b64_tr_b16 v[114:115], v140 offset:11520
    v_exp_f32 v39, v31
    v_exp_f32 v40, v32
    s_waitcnt lgkmcnt(7)
    v_exp_f32 v41, v33
    v_smfmac_f32_32x32x32_bf16 v[64:79], v[52:55], v[20:27], v167
    ds_read_b128 v[52:55], v138 offset:0
    v_exp_f32 v42, v34
    v_exp_f32 v43, v35
    v_add_u32 v143, s70, v143
    s_waitcnt lgkmcnt(7)
    v_mfma_f32_32x32x16_bf16 v[20:35], v[44:47], v[60:63], 0
    ds_read_b128 v[44:47], v136 offset:5632
    v_exp_f32 v4, v4
    v_exp_f32 v5, v5
    v_mfma_f32_32x32x16_bf16 v[96:111], v[132:135], v[124:127], v[96:111]
    ds_read_b128 v[132:135], v144 offset:4096
    v_exp_f32 v6, v6
    v_exp_f32 v7, v7
    s_waitcnt lgkmcnt(7)
    v_exp_f32 v8, v8
    v_mfma_f32_32x32x8_bf16 v[20:35], v[48:49], v[50:51], v[20:35]
    ds_read_b64 v[48:49], v137 offset:5632
    v_exp_f32 v9, v9
    v_exp_f32 v10, v10
    s_waitcnt lgkmcnt(7)
    v_exp_f32 v11, v11
    v_smfmac_f32_32x32x32_bf16 v[64:79], v[56:59], v[36:43], v167
    ds_read_b128 v[56:59], v139 offset:0
    v_exp_f32 v36, v12
    v_exp_f32 v37, v13
    v_exp_f32_e64 v38, v14
    v_mfma_f32_32x32x16_bf16 v[80:95], v[128:131], v[124:127], v[80:95]
    ds_read_b128 v[128:131], v144 offset:0
    ds_read_b64_tr_b16 v[124:125], v140 offset:15360
    ds_read_b64_tr_b16 v[126:127], v140 offset:16640
    v_exp_f32 v39, v15
    v_exp_f32 v40, v16
    s_waitcnt lgkmcnt(7)
    v_exp_f32 v41, v17
    v_smfmac_f32_32x32x32_bf16 v[64:79], v[52:55], v[4:11], v167
    ds_read_b128 v[52:55], v138 offset:2816
    v_exp_f32 v42, v18
    v_exp_f32 v43, v19
    v_add_u32 v144, s70, v144
    v_add_u32 v140, s70, v140
    s_waitcnt lgkmcnt(1)
    s_barrier
    v_mfma_f32_32x32x16_bf16 v[4:19], v[44:47], v[60:63], 0
    ds_read_b128 v[44:47], v136 offset:8448
    v_exp_f32 v20, v20
    v_exp_f32 v21, v21
    v_smfmac_f32_32x32x32_bf16 v[64:79], v[56:59], v[36:43], v167
    ds_read_b128 v[56:59], v139 offset:2816
    v_exp_f32_e64 v22, v22
    v_mfma_f32_32x32x8_bf16 v[4:19], v[48:49], v[50:51], v[4:19]
    ds_read_b64 v[48:49], v137 offset:8448
    v_exp_f32 v23, v23
    v_exp_f32 v24, v24
    v_mfma_f32_32x32x16_bf16 v[80:95], v[128:131], v[124:127], v[80:95]
    ds_read_b128 v[128:131], v142 offset:0
    v_exp_f32 v25, v25
    v_exp_f32 v26, v26
    v_mfma_f32_32x32x16_bf16 v[96:111], v[120:123], v[112:115], v[96:111]
    ds_read_b128 v[120:123], v141 offset:4096
    v_exp_f32 v27, v27
    v_exp_f32 v36, v28
    v_exp_f32_e64 v37, v29
    v_mfma_f32_32x32x16_bf16 v[96:111], v[132:135], v[124:127], v[96:111]
    ds_read_b128 v[132:135], v142 offset:4096
    ds_read_b64_tr_b16 v[124:125], v140 offset:5120
    ds_read_b64_tr_b16 v[126:127], v140 offset:6400
    v_exp_f32_e64 v38, v30
    v_mfma_f32_32x32x16_bf16 v[80:95], v[116:119], v[112:115], v[80:95]
    ds_read_b128 v[116:119], v141 offset:0
    ds_read_b64_tr_b16 v[112:113], v140 offset:0
    ds_read_b64_tr_b16 v[114:115], v140 offset:1280
    v_exp_f32 v39, v31
    v_exp_f32 v40, v32
    s_waitcnt lgkmcnt(11)
    v_exp_f32 v41, v33
    v_smfmac_f32_32x32x32_bf16 v[64:79], v[52:55], v[20:27], v167
    ds_read_b128 v[52:55], v138 offset:5632
    v_exp_f32 v42, v34
    v_exp_f32 v43, v35
    v_add_u32 v141, s74, v141
    v_add_u32 v142, s74, v142
    s_waitcnt lgkmcnt(11)
    s_nop 0
    v_mfma_f32_32x32x16_bf16 v[20:35], v[44:47], v[60:63], 0
    ds_read_b128 v[44:47], v136 offset:11264
    v_exp_f32 v4, v4
    s_waitcnt lgkmcnt(2)
    v_exp_f32_e64 v5, v5
    v_mfma_f32_32x32x16_bf16 v[96:111], v[120:123], v[112:115], v[96:111]
    ds_read_b128 v[120:123], v143 offset:4096
    v_exp_f32 v6, v6
    v_exp_f32 v7, v7
    v_exp_f32_e64 v8, v8
    v_mfma_f32_32x32x8_bf16 v[20:35], v[48:49], v[50:51], v[20:35]
    ds_read_b64 v[48:49], v137 offset:11264
    v_exp_f32 v9, v9
    v_exp_f32 v10, v10
    v_exp_f32_e64 v11, v11
    v_smfmac_f32_32x32x32_bf16 v[64:79], v[56:59], v[36:43], v167
    ds_read_b128 v[56:59], v139 offset:5632
    v_exp_f32 v36, v12
    v_exp_f32 v37, v13
    v_exp_f32_e64 v38, v14
    v_mfma_f32_32x32x16_bf16 v[80:95], v[116:119], v[112:115], v[80:95]
    ds_read_b128 v[116:119], v143 offset:0
    ds_read_b64_tr_b16 v[112:113], v140 offset:10240
    ds_read_b64_tr_b16 v[114:115], v140 offset:11520
    v_exp_f32 v39, v15
    v_exp_f32 v40, v16
    s_waitcnt lgkmcnt(7)
    v_exp_f32 v41, v17
    v_smfmac_f32_32x32x32_bf16 v[64:79], v[52:55], v[4:11], v167
    ds_read_b128 v[52:55], v138 offset:8448
    v_exp_f32 v42, v18
    v_exp_f32 v43, v19
    v_add_u32 v143, s74, v143
    s_waitcnt lgkmcnt(7)
    v_mfma_f32_32x32x16_bf16 v[4:19], v[44:47], v[60:63], 0
    ds_read_b128 v[44:47], v136 offset:14080
    v_exp_f32 v20, v20
    v_exp_f32 v21, v21
    v_mfma_f32_32x32x16_bf16 v[96:111], v[132:135], v[124:127], v[96:111]
    ds_read_b128 v[132:135], v144 offset:4096
    v_exp_f32 v22, v22
    v_exp_f32 v23, v23
    s_waitcnt lgkmcnt(7)
    v_exp_f32 v24, v24
    v_mfma_f32_32x32x8_bf16 v[4:19], v[48:49], v[50:51], v[4:19]
    ds_read_b64 v[48:49], v137 offset:14080
    v_exp_f32 v25, v25
    v_exp_f32 v26, v26
    s_waitcnt lgkmcnt(7)
    v_exp_f32 v27, v27
    v_smfmac_f32_32x32x32_bf16 v[64:79], v[56:59], v[36:43], v167
    ds_read_b128 v[56:59], v139 offset:8448
    v_exp_f32 v36, v28
    v_exp_f32 v37, v29
    v_exp_f32_e64 v38, v30
    v_mfma_f32_32x32x16_bf16 v[80:95], v[128:131], v[124:127], v[80:95]
    ds_read_b128 v[128:131], v144 offset:0
    ds_read_b64_tr_b16 v[124:125], v140 offset:15360
    ds_read_b64_tr_b16 v[126:127], v140 offset:16640
    v_exp_f32 v39, v31
    v_exp_f32 v40, v32
    s_waitcnt lgkmcnt(7)
    v_exp_f32 v41, v33
    v_smfmac_f32_32x32x32_bf16 v[64:79], v[52:55], v[20:27], v167
    ds_read_b128 v[52:55], v138 offset:11264
    v_exp_f32 v42, v34
    v_exp_f32 v43, v35
    v_add_u32 v144, s74, v144
    v_add_u32 v140, s74, v140
    s_waitcnt lgkmcnt(1)
    s_barrier
    v_mfma_f32_32x32x16_bf16 v[20:35], v[44:47], v[60:63], 0
    ds_read_b128 v[44:47], v136 offset:16896
    v_exp_f32 v4, v4
    v_exp_f32 v5, v5
    v_smfmac_f32_32x32x32_bf16 v[64:79], v[56:59], v[36:43], v167
    ds_read_b128 v[56:59], v139 offset:11264
    v_exp_f32_e64 v6, v6
    v_mfma_f32_32x32x8_bf16 v[20:35], v[48:49], v[50:51], v[20:35]
    ds_read_b64 v[48:49], v137 offset:16896
    v_exp_f32 v7, v7
    v_exp_f32 v8, v8
    v_mfma_f32_32x32x16_bf16 v[80:95], v[128:131], v[124:127], v[80:95]
    ds_read_b128 v[128:131], v142 offset:0
    v_exp_f32 v9, v9
    v_exp_f32 v10, v10
    v_mfma_f32_32x32x16_bf16 v[96:111], v[120:123], v[112:115], v[96:111]
    ds_read_b128 v[120:123], v141 offset:4096
    v_exp_f32 v11, v11
    v_exp_f32 v36, v12
    v_exp_f32_e64 v37, v13
    v_mfma_f32_32x32x16_bf16 v[96:111], v[132:135], v[124:127], v[96:111]
    ds_read_b128 v[132:135], v142 offset:4096
    ds_read_b64_tr_b16 v[124:125], v140 offset:5120
    ds_read_b64_tr_b16 v[126:127], v140 offset:6400
    v_exp_f32_e64 v38, v14
    v_mfma_f32_32x32x16_bf16 v[80:95], v[116:119], v[112:115], v[80:95]
    ds_read_b128 v[116:119], v141 offset:0
    ds_read_b64_tr_b16 v[112:113], v140 offset:0
    ds_read_b64_tr_b16 v[114:115], v140 offset:1280
    v_exp_f32 v39, v15
    v_exp_f32 v40, v16
    s_waitcnt lgkmcnt(11)
    v_exp_f32 v41, v17
    v_smfmac_f32_32x32x32_bf16 v[64:79], v[52:55], v[4:11], v167
    ds_read_b128 v[52:55], v138 offset:14080
    v_exp_f32 v42, v18
    v_exp_f32 v43, v19
    v_add_u32 v141, s70, v141
    v_add_u32 v142, s70, v142
    s_waitcnt lgkmcnt(11)
    s_nop 0
    v_mfma_f32_32x32x16_bf16 v[4:19], v[44:47], v[60:63], 0
    ds_read_b128 v[44:47], v136 offset:19712
    v_exp_f32 v20, v20
    s_waitcnt lgkmcnt(2)
    v_exp_f32_e64 v21, v21
    v_mfma_f32_32x32x16_bf16 v[96:111], v[120:123], v[112:115], v[96:111]
    ds_read_b128 v[120:123], v143 offset:4096
    v_exp_f32 v22, v22
    v_exp_f32 v23, v23
    v_exp_f32_e64 v24, v24
    v_mfma_f32_32x32x8_bf16 v[4:19], v[48:49], v[50:51], v[4:19]
    ds_read_b64 v[48:49], v137 offset:19712
    v_exp_f32 v25, v25
    v_exp_f32 v26, v26
    v_exp_f32_e64 v27, v27
    v_smfmac_f32_32x32x32_bf16 v[64:79], v[56:59], v[36:43], v167
    ds_read_b128 v[56:59], v139 offset:14080
    v_exp_f32 v36, v28
    v_exp_f32 v37, v29
    v_exp_f32_e64 v38, v30
    v_mfma_f32_32x32x16_bf16 v[80:95], v[116:119], v[112:115], v[80:95]
    ds_read_b128 v[116:119], v143 offset:0
    ds_read_b64_tr_b16 v[112:113], v140 offset:10240
    ds_read_b64_tr_b16 v[114:115], v140 offset:11520
    v_exp_f32 v39, v31
    v_exp_f32 v40, v32
    s_waitcnt lgkmcnt(7)
    v_exp_f32 v41, v33
    v_smfmac_f32_32x32x32_bf16 v[64:79], v[52:55], v[20:27], v167
    ds_read_b128 v[52:55], v138 offset:16896
    v_exp_f32 v42, v34
    v_exp_f32 v43, v35
    v_add_u32 v143, s70, v143
    s_waitcnt lgkmcnt(7)
    v_mfma_f32_32x32x16_bf16 v[20:35], v[44:47], v[60:63], 0
    ds_read_b128 v[44:47], v136 offset:22528
    v_exp_f32 v4, v4
    v_exp_f32 v5, v5
    v_mfma_f32_32x32x16_bf16 v[96:111], v[132:135], v[124:127], v[96:111]
    ds_read_b128 v[132:135], v144 offset:4096
    v_exp_f32 v6, v6
    v_exp_f32 v7, v7
    s_waitcnt lgkmcnt(7)
    v_exp_f32 v8, v8
    v_mfma_f32_32x32x8_bf16 v[20:35], v[48:49], v[50:51], v[20:35]
    ds_read_b64 v[48:49], v137 offset:22528
    v_exp_f32 v9, v9
    v_exp_f32 v10, v10
    s_waitcnt lgkmcnt(7)
    v_exp_f32 v11, v11
    v_smfmac_f32_32x32x32_bf16 v[64:79], v[56:59], v[36:43], v167
    ds_read_b128 v[56:59], v139 offset:16896
    v_exp_f32 v36, v12
    v_exp_f32 v37, v13
    v_exp_f32_e64 v38, v14
    v_mfma_f32_32x32x16_bf16 v[80:95], v[128:131], v[124:127], v[80:95]
    ds_read_b128 v[128:131], v144 offset:0
    ds_read_b64_tr_b16 v[124:125], v140 offset:15360
    ds_read_b64_tr_b16 v[126:127], v140 offset:16640
    v_exp_f32 v39, v15
    v_exp_f32 v40, v16
    s_waitcnt lgkmcnt(7)
    v_exp_f32 v41, v17
    v_smfmac_f32_32x32x32_bf16 v[64:79], v[52:55], v[4:11], v167
    ds_read_b128 v[52:55], v138 offset:19712
    v_exp_f32 v42, v18
    v_exp_f32 v43, v19
    v_add_u32 v144, s70, v144
    v_add_u32 v140, s70, v140
    s_waitcnt lgkmcnt(1)
    s_barrier
    v_mfma_f32_32x32x16_bf16 v[4:19], v[44:47], v[60:63], 0
    ds_read_b128 v[44:47], v136 offset:25344
    v_exp_f32 v20, v20
    v_exp_f32 v21, v21
    v_smfmac_f32_32x32x32_bf16 v[64:79], v[56:59], v[36:43], v167
    ds_read_b128 v[56:59], v139 offset:19712
    v_exp_f32_e64 v22, v22
    v_mfma_f32_32x32x8_bf16 v[4:19], v[48:49], v[50:51], v[4:19]
    ds_read_b64 v[48:49], v137 offset:25344
    v_exp_f32 v23, v23
    v_exp_f32 v24, v24
    v_mfma_f32_32x32x16_bf16 v[80:95], v[128:131], v[124:127], v[80:95]
    ds_read_b128 v[128:131], v142 offset:0
    v_exp_f32 v25, v25
    v_exp_f32 v26, v26
    v_mfma_f32_32x32x16_bf16 v[96:111], v[120:123], v[112:115], v[96:111]
    ds_read_b128 v[120:123], v141 offset:4096
    v_exp_f32 v27, v27
    v_exp_f32 v36, v28
    v_exp_f32_e64 v37, v29
    v_mfma_f32_32x32x16_bf16 v[96:111], v[132:135], v[124:127], v[96:111]
    ds_read_b128 v[132:135], v142 offset:4096
    ds_read_b64_tr_b16 v[124:125], v140 offset:5120
    ds_read_b64_tr_b16 v[126:127], v140 offset:6400
    v_exp_f32_e64 v38, v30
    v_mfma_f32_32x32x16_bf16 v[80:95], v[116:119], v[112:115], v[80:95]
    ds_read_b128 v[116:119], v141 offset:0
    ds_read_b64_tr_b16 v[112:113], v140 offset:0
    ds_read_b64_tr_b16 v[114:115], v140 offset:1280
    v_exp_f32 v39, v31
    v_exp_f32 v40, v32
    s_waitcnt lgkmcnt(11)
    v_exp_f32 v41, v33
    v_smfmac_f32_32x32x32_bf16 v[64:79], v[52:55], v[20:27], v167
    ds_read_b128 v[52:55], v138 offset:22528
    v_exp_f32 v42, v34
    v_exp_f32 v43, v35
    v_add_u32 v141, s70, v141
    v_add_u32 v142, s70, v142
    s_waitcnt lgkmcnt(11)
    s_nop 0
    v_mfma_f32_32x32x16_bf16 v[20:35], v[44:47], v[60:63], 0
    ds_read_b128 v[44:47], v136 offset:28160
    v_exp_f32 v4, v4
    s_waitcnt lgkmcnt(11)
    v_exp_f32_e64 v5, v5
    v_smfmac_f32_32x32x32_bf16 v[64:79], v[56:59], v[36:43], v167
    ds_read_b128 v[56:59], v139 offset:22528
    s_waitcnt lgkmcnt(11)
    v_exp_f32 v6, v6
    v_mfma_f32_32x32x8_bf16 v[20:35], v[48:49], v[50:51], v[20:35]
    ds_read_b64 v[48:49], v137 offset:28160
    v_exp_f32 v7, v7
    s_waitcnt lgkmcnt(7)
    v_exp_f32_e64 v8, v8
    v_mfma_f32_32x32x16_bf16 v[80:95], v[128:131], v[124:127], v[80:95]
    ds_read_b128 v[128:131], v144 offset:0
    v_exp_f32 v9, v9
    s_waitcnt lgkmcnt(5)
    v_exp_f32_e64 v10, v10
    v_mfma_f32_32x32x16_bf16 v[96:111], v[120:123], v[112:115], v[96:111]
    ds_read_b128 v[120:123], v143 offset:4096
    v_exp_f32 v11, v11
    v_exp_f32 v36, v12
    v_exp_f32_e64 v37, v13
    v_mfma_f32_32x32x16_bf16 v[96:111], v[132:135], v[124:127], v[96:111]
    ds_read_b128 v[132:135], v144 offset:4096
    ds_read_b64_tr_b16 v[124:125], v140 offset:15360
    ds_read_b64_tr_b16 v[126:127], v140 offset:16640
    v_exp_f32_e64 v38, v14
    v_mfma_f32_32x32x16_bf16 v[80:95], v[116:119], v[112:115], v[80:95]
    ds_read_b128 v[116:119], v143 offset:0
    ds_read_b64_tr_b16 v[112:113], v140 offset:10240
    ds_read_b64_tr_b16 v[114:115], v140 offset:11520
    v_exp_f32 v39, v15
    v_exp_f32 v40, v16
    s_waitcnt lgkmcnt(11)
    v_exp_f32 v41, v17
    v_smfmac_f32_32x32x32_bf16 v[64:79], v[52:55], v[4:11], v167
    ds_read_b128 v[52:55], v138 offset:25344
    v_exp_f32 v42, v18
    v_exp_f32 v43, v19
    v_add_u32 v143, s70, v143
    v_add_u32 v144, s70, v144
    v_add_u32 v140, s70, v140
    s_waitcnt lgkmcnt(1)
    s_barrier
    s_nop 0
    v_mfma_f32_32x32x16_bf16 v[4:19], v[44:47], v[60:63], 0
    ds_read_b128 v[44:47], v136 offset:30976
    v_exp_f32 v20, v20
    v_exp_f32 v21, v21
    v_smfmac_f32_32x32x32_bf16 v[64:79], v[56:59], v[36:43], v167
    ds_read_b128 v[56:59], v139 offset:25344
    v_exp_f32_e64 v22, v22
    v_mfma_f32_32x32x8_bf16 v[4:19], v[48:49], v[50:51], v[4:19]
    ds_read_b64 v[48:49], v137 offset:30976
    v_exp_f32 v23, v23
    v_exp_f32 v24, v24
    v_mfma_f32_32x32x16_bf16 v[80:95], v[128:131], v[124:127], v[80:95]
    ds_read_b128 v[128:131], v142 offset:0
    v_exp_f32 v25, v25
    v_exp_f32 v26, v26
    v_mfma_f32_32x32x16_bf16 v[96:111], v[120:123], v[112:115], v[96:111]
    ds_read_b128 v[120:123], v141 offset:4096
    v_exp_f32 v27, v27
    v_exp_f32 v36, v28
    v_exp_f32_e64 v37, v29
    v_mfma_f32_32x32x16_bf16 v[96:111], v[132:135], v[124:127], v[96:111]
    ds_read_b128 v[132:135], v142 offset:4096
    ds_read_b64_tr_b16 v[124:125], v140 offset:5120
    ds_read_b64_tr_b16 v[126:127], v140 offset:6400
    v_exp_f32_e64 v38, v30
    v_mfma_f32_32x32x16_bf16 v[80:95], v[116:119], v[112:115], v[80:95]
    ds_read_b128 v[116:119], v141 offset:0
    ds_read_b64_tr_b16 v[112:113], v140 offset:0
    ds_read_b64_tr_b16 v[114:115], v140 offset:1280
    v_exp_f32 v39, v31
    v_exp_f32 v40, v32
    s_waitcnt lgkmcnt(11)
    v_exp_f32 v41, v33
    v_smfmac_f32_32x32x32_bf16 v[64:79], v[52:55], v[20:27], v167
    ds_read_b128 v[52:55], v138 offset:28160
    v_exp_f32 v42, v34
    v_exp_f32 v43, v35
    v_add_u32 v141, s74, v141
    v_add_u32 v142, s74, v142
    s_waitcnt lgkmcnt(11)
    s_nop 0
    v_mfma_f32_32x32x16_bf16 v[20:35], v[44:47], v[60:63], 0
    ds_read_b128 v[44:47], v136 offset:33792
    v_exp_f32 v4, v4
    s_waitcnt lgkmcnt(11)
    v_exp_f32_e64 v5, v5
    v_smfmac_f32_32x32x32_bf16 v[64:79], v[56:59], v[36:43], v167
    ds_read_b128 v[56:59], v139 offset:28160
    s_waitcnt lgkmcnt(11)
    v_exp_f32 v6, v6
    v_mfma_f32_32x32x8_bf16 v[20:35], v[48:49], v[50:51], v[20:35]
    ds_read_b64 v[48:49], v137 offset:33792
    v_exp_f32 v7, v7
    s_waitcnt lgkmcnt(7)
    v_exp_f32_e64 v8, v8
    v_mfma_f32_32x32x16_bf16 v[80:95], v[128:131], v[124:127], v[80:95]
    ds_read_b128 v[128:131], v144 offset:0
    v_exp_f32 v9, v9
    s_waitcnt lgkmcnt(5)
    v_exp_f32_e64 v10, v10
    v_mfma_f32_32x32x16_bf16 v[96:111], v[120:123], v[112:115], v[96:111]
    ds_read_b128 v[120:123], v143 offset:4096
    v_exp_f32 v11, v11
    v_exp_f32 v36, v12
    v_exp_f32_e64 v37, v13
    v_mfma_f32_32x32x16_bf16 v[96:111], v[132:135], v[124:127], v[96:111]
    ds_read_b128 v[132:135], v144 offset:4096
    ds_read_b64_tr_b16 v[124:125], v140 offset:15360
    ds_read_b64_tr_b16 v[126:127], v140 offset:16640
    v_exp_f32_e64 v38, v14
    v_mfma_f32_32x32x16_bf16 v[80:95], v[116:119], v[112:115], v[80:95]
    ds_read_b128 v[116:119], v143 offset:0
    ds_read_b64_tr_b16 v[112:113], v140 offset:10240
    ds_read_b64_tr_b16 v[114:115], v140 offset:11520
    v_exp_f32 v39, v15
    v_exp_f32 v40, v16
    s_waitcnt lgkmcnt(11)
    v_exp_f32 v41, v17
    v_smfmac_f32_32x32x32_bf16 v[64:79], v[52:55], v[4:11], v167
    ds_read_b128 v[52:55], v138 offset:30976
    v_exp_f32 v42, v18
    v_exp_f32 v43, v19
    v_add_u32 v143, s74, v143
    v_add_u32 v144, s74, v144
    v_add_u32 v140, s74, v140
    s_waitcnt lgkmcnt(1)
    s_barrier
    s_nop 0
    v_mfma_f32_32x32x16_bf16 v[4:19], v[44:47], v[60:63], 0
    ds_read_b128 v[44:47], v136 offset:36608
    v_exp_f32 v20, v20
    v_exp_f32 v21, v21
    v_smfmac_f32_32x32x32_bf16 v[64:79], v[56:59], v[36:43], v167
    ds_read_b128 v[56:59], v139 offset:30976
    v_exp_f32_e64 v22, v22
    v_mfma_f32_32x32x8_bf16 v[4:19], v[48:49], v[50:51], v[4:19]
    ds_read_b64 v[48:49], v137 offset:36608
    v_exp_f32 v23, v23
    v_exp_f32 v24, v24
    v_mfma_f32_32x32x16_bf16 v[80:95], v[128:131], v[124:127], v[80:95]
    ds_read_b128 v[128:131], v142 offset:0
    v_exp_f32 v25, v25
    v_exp_f32 v26, v26
    v_mfma_f32_32x32x16_bf16 v[96:111], v[120:123], v[112:115], v[96:111]
    ds_read_b128 v[120:123], v141 offset:4096
    v_exp_f32 v27, v27
    v_exp_f32 v36, v28
    v_exp_f32_e64 v37, v29
    v_mfma_f32_32x32x16_bf16 v[96:111], v[132:135], v[124:127], v[96:111]
    ds_read_b128 v[132:135], v142 offset:4096
    ds_read_b64_tr_b16 v[124:125], v140 offset:5120
    ds_read_b64_tr_b16 v[126:127], v140 offset:6400
    v_exp_f32_e64 v38, v30
    v_mfma_f32_32x32x16_bf16 v[80:95], v[116:119], v[112:115], v[80:95]
    ds_read_b128 v[116:119], v141 offset:0
    ds_read_b64_tr_b16 v[112:113], v140 offset:0
    ds_read_b64_tr_b16 v[114:115], v140 offset:1280
    v_exp_f32 v39, v31
    v_exp_f32 v40, v32
    s_waitcnt lgkmcnt(11)
    v_exp_f32 v41, v33
    v_smfmac_f32_32x32x32_bf16 v[64:79], v[52:55], v[20:27], v167
    ds_read_b128 v[52:55], v138 offset:33792
    v_exp_f32 v42, v34
    v_exp_f32 v43, v35
    v_add_u32 v141, s70, v141
    v_add_u32 v142, s70, v142
    s_waitcnt lgkmcnt(11)
    s_nop 0
    v_mfma_f32_32x32x16_bf16 v[20:35], v[44:47], v[60:63], 0
    ds_read_b128 v[44:47], v136 offset:39424
    v_exp_f32 v4, v4
    s_waitcnt lgkmcnt(11)
    v_exp_f32_e64 v5, v5
    v_smfmac_f32_32x32x32_bf16 v[64:79], v[56:59], v[36:43], v167
    ds_read_b128 v[56:59], v139 offset:33792
    s_waitcnt lgkmcnt(11)
    v_exp_f32 v6, v6
    v_mfma_f32_32x32x8_bf16 v[20:35], v[48:49], v[50:51], v[20:35]
    ds_read_b64 v[48:49], v137 offset:39424
    v_exp_f32 v7, v7
    s_waitcnt lgkmcnt(7)
    v_exp_f32_e64 v8, v8
    v_mfma_f32_32x32x16_bf16 v[80:95], v[128:131], v[124:127], v[80:95]
    ds_read_b128 v[128:131], v144 offset:0
    v_exp_f32 v9, v9
    s_waitcnt lgkmcnt(5)
    v_exp_f32_e64 v10, v10
    v_mfma_f32_32x32x16_bf16 v[96:111], v[120:123], v[112:115], v[96:111]
    ds_read_b128 v[120:123], v143 offset:4096
    v_exp_f32 v11, v11
    v_exp_f32 v36, v12
    v_exp_f32_e64 v37, v13
    v_mfma_f32_32x32x16_bf16 v[96:111], v[132:135], v[124:127], v[96:111]
    ds_read_b128 v[132:135], v144 offset:4096
    ds_read_b64_tr_b16 v[124:125], v140 offset:15360
    ds_read_b64_tr_b16 v[126:127], v140 offset:16640
    v_exp_f32_e64 v38, v14
    v_mfma_f32_32x32x16_bf16 v[80:95], v[116:119], v[112:115], v[80:95]
    ds_read_b128 v[116:119], v143 offset:0
    ds_read_b64_tr_b16 v[112:113], v140 offset:10240
    ds_read_b64_tr_b16 v[114:115], v140 offset:11520
    v_exp_f32 v39, v15
    v_exp_f32 v40, v16
    s_waitcnt lgkmcnt(11)
    v_exp_f32 v41, v17
    v_smfmac_f32_32x32x32_bf16 v[64:79], v[52:55], v[4:11], v167
    ds_read_b128 v[52:55], v138 offset:36608
    v_exp_f32 v42, v18
    v_exp_f32 v43, v19
    v_add_u32 v143, s70, v143
    v_add_u32 v144, s70, v144
    v_add_u32 v140, s70, v140
    s_waitcnt lgkmcnt(1)
    s_barrier
    s_nop 0
    v_mfma_f32_32x32x16_bf16 v[4:19], v[44:47], v[60:63], 0
    ds_read_b128 v[44:47], v136 offset:42240
    v_exp_f32 v20, v20
    v_exp_f32 v21, v21
    v_smfmac_f32_32x32x32_bf16 v[64:79], v[56:59], v[36:43], v167
    ds_read_b128 v[56:59], v139 offset:36608
    v_exp_f32_e64 v22, v22
    v_mfma_f32_32x32x8_bf16 v[4:19], v[48:49], v[50:51], v[4:19]
    ds_read_b64 v[48:49], v137 offset:42240
    v_exp_f32 v23, v23
    v_exp_f32 v24, v24
    v_mfma_f32_32x32x16_bf16 v[80:95], v[128:131], v[124:127], v[80:95]
    ds_read_b128 v[128:131], v142 offset:0
    v_exp_f32 v25, v25
    v_exp_f32 v26, v26
    v_mfma_f32_32x32x16_bf16 v[96:111], v[120:123], v[112:115], v[96:111]
    ds_read_b128 v[120:123], v141 offset:4096
    v_exp_f32 v27, v27
    v_exp_f32 v36, v28
    v_exp_f32_e64 v37, v29
    v_mfma_f32_32x32x16_bf16 v[96:111], v[132:135], v[124:127], v[96:111]
    ds_read_b128 v[132:135], v142 offset:4096
    ds_read_b64_tr_b16 v[124:125], v140 offset:5120
    ds_read_b64_tr_b16 v[126:127], v140 offset:6400
    v_exp_f32_e64 v38, v30
    v_mfma_f32_32x32x16_bf16 v[80:95], v[116:119], v[112:115], v[80:95]
    ds_read_b128 v[116:119], v141 offset:0
    ds_read_b64_tr_b16 v[112:113], v140 offset:0
    ds_read_b64_tr_b16 v[114:115], v140 offset:1280
    v_exp_f32 v39, v31
    v_exp_f32 v40, v32
    s_waitcnt lgkmcnt(11)
    v_exp_f32 v41, v33
    v_smfmac_f32_32x32x32_bf16 v[64:79], v[52:55], v[20:27], v167
    ds_read_b128 v[52:55], v138 offset:39424
    v_exp_f32 v42, v34
    v_exp_f32 v43, v35
    v_add_u32 v141, s70, v141
    v_add_u32 v142, s70, v142
    s_waitcnt lgkmcnt(11)
    s_nop 0
    v_mfma_f32_32x32x16_bf16 v[20:35], v[44:47], v[60:63], 0
    ds_read_b128 v[44:47], v136 offset:0
    v_exp_f32 v4, v4
    s_waitcnt lgkmcnt(11)
    v_exp_f32_e64 v5, v5
    v_smfmac_f32_32x32x32_bf16 v[64:79], v[56:59], v[36:43], v167
    ds_read_b128 v[56:59], v139 offset:39424
    s_waitcnt lgkmcnt(11)
    v_exp_f32 v6, v6
    v_mfma_f32_32x32x8_bf16 v[20:35], v[48:49], v[50:51], v[20:35]
    ds_read_b64 v[48:49], v137 offset:0
    v_exp_f32 v7, v7
    s_waitcnt lgkmcnt(7)
    v_exp_f32_e64 v8, v8
    v_mfma_f32_32x32x16_bf16 v[80:95], v[128:131], v[124:127], v[80:95]
    ds_read_b128 v[128:131], v144 offset:0
    v_exp_f32 v9, v9
    s_waitcnt lgkmcnt(5)
    v_exp_f32_e64 v10, v10
    v_mfma_f32_32x32x16_bf16 v[96:111], v[120:123], v[112:115], v[96:111]
    ds_read_b128 v[120:123], v143 offset:4096
    v_exp_f32 v11, v11
    v_exp_f32 v36, v12
    v_exp_f32_e64 v37, v13
    v_mfma_f32_32x32x16_bf16 v[96:111], v[132:135], v[124:127], v[96:111]
    ds_read_b128 v[132:135], v144 offset:4096
    ds_read_b64_tr_b16 v[124:125], v140 offset:15360
    ds_read_b64_tr_b16 v[126:127], v140 offset:16640
    v_exp_f32_e64 v38, v14
    v_mfma_f32_32x32x16_bf16 v[80:95], v[116:119], v[112:115], v[80:95]
    ds_read_b128 v[116:119], v143 offset:0
    ds_read_b64_tr_b16 v[112:113], v140 offset:10240
    ds_read_b64_tr_b16 v[114:115], v140 offset:11520
    v_exp_f32 v39, v15
    v_exp_f32 v40, v16
    s_waitcnt lgkmcnt(11)
    v_exp_f32 v41, v17
    v_smfmac_f32_32x32x32_bf16 v[64:79], v[52:55], v[4:11], v167
    ds_read_b128 v[52:55], v138 offset:42240
    v_exp_f32 v42, v18
    v_exp_f32 v43, v19
    v_add_u32 v143, s70, v143
    v_add_u32 v144, s70, v144
    v_add_u32 v140, s70, v140
    s_waitcnt lgkmcnt(1)
    s_barrier
    s_nop 0
    v_mfma_f32_32x32x16_bf16 v[4:19], v[44:47], v[60:63], 0
    ds_read_b128 v[44:47], v136 offset:2816
    v_exp_f32 v20, v20
    v_exp_f32 v21, v21
    v_smfmac_f32_32x32x32_bf16 v[64:79], v[56:59], v[36:43], v167
    ds_read_b128 v[56:59], v139 offset:42240
    v_exp_f32_e64 v22, v22
    v_mfma_f32_32x32x8_bf16 v[4:19], v[48:49], v[50:51], v[4:19]
    ds_read_b64 v[48:49], v137 offset:2816
    v_exp_f32 v23, v23
    v_exp_f32 v24, v24
    v_mfma_f32_32x32x16_bf16 v[80:95], v[128:131], v[124:127], v[80:95]
    ds_read_b128 v[128:131], v142 offset:0
    v_exp_f32 v25, v25
    v_exp_f32 v26, v26
    v_mfma_f32_32x32x16_bf16 v[96:111], v[120:123], v[112:115], v[96:111]
    ds_read_b128 v[120:123], v141 offset:4096
    v_exp_f32 v27, v27
    v_exp_f32 v36, v28
    v_exp_f32_e64 v37, v29
    v_mfma_f32_32x32x16_bf16 v[96:111], v[132:135], v[124:127], v[96:111]
    ds_read_b128 v[132:135], v142 offset:4096
    ds_read_b64_tr_b16 v[124:125], v140 offset:5120
    ds_read_b64_tr_b16 v[126:127], v140 offset:6400
    v_exp_f32_e64 v38, v30
    v_mfma_f32_32x32x16_bf16 v[80:95], v[116:119], v[112:115], v[80:95]
    ds_read_b128 v[116:119], v141 offset:0
    ds_read_b64_tr_b16 v[112:113], v140 offset:0
    ds_read_b64_tr_b16 v[114:115], v140 offset:1280
    v_exp_f32 v39, v31
    v_exp_f32 v40, v32
    s_waitcnt lgkmcnt(11)
    v_exp_f32 v41, v33
    v_smfmac_f32_32x32x32_bf16 v[64:79], v[52:55], v[20:27], v167
    ds_read_b128 v[52:55], v138 offset:0
    v_exp_f32 v42, v34
    v_exp_f32 v43, v35
    v_add_u32 v141, s74, v141
    v_add_u32 v142, s74, v142
    s_waitcnt lgkmcnt(11)
    s_nop 0
    v_mfma_f32_32x32x16_bf16 v[20:35], v[44:47], v[60:63], 0
    ds_read_b128 v[44:47], v136 offset:5632
    v_exp_f32 v4, v4
    s_waitcnt lgkmcnt(11)
    v_exp_f32_e64 v5, v5
    v_smfmac_f32_32x32x32_bf16 v[64:79], v[56:59], v[36:43], v167
    ds_read_b128 v[56:59], v139 offset:0
    s_waitcnt lgkmcnt(11)
    v_exp_f32 v6, v6
    v_mfma_f32_32x32x8_bf16 v[20:35], v[48:49], v[50:51], v[20:35]
    ds_read_b64 v[48:49], v137 offset:5632
    v_exp_f32 v7, v7
    s_waitcnt lgkmcnt(7)
    v_exp_f32_e64 v8, v8
    v_mfma_f32_32x32x16_bf16 v[80:95], v[128:131], v[124:127], v[80:95]
    ds_read_b128 v[128:131], v144 offset:0
    v_exp_f32 v9, v9
    s_waitcnt lgkmcnt(5)
    v_exp_f32_e64 v10, v10
    v_mfma_f32_32x32x16_bf16 v[96:111], v[120:123], v[112:115], v[96:111]
    ds_read_b128 v[120:123], v143 offset:4096
    v_exp_f32 v11, v11
    v_exp_f32 v36, v12
    v_exp_f32_e64 v37, v13
    v_mfma_f32_32x32x16_bf16 v[96:111], v[132:135], v[124:127], v[96:111]
    ds_read_b128 v[132:135], v144 offset:4096
    ds_read_b64_tr_b16 v[124:125], v140 offset:15360
    ds_read_b64_tr_b16 v[126:127], v140 offset:16640
    v_exp_f32_e64 v38, v14
    v_mfma_f32_32x32x16_bf16 v[80:95], v[116:119], v[112:115], v[80:95]
    ds_read_b128 v[116:119], v143 offset:0
    ds_read_b64_tr_b16 v[112:113], v140 offset:10240
    ds_read_b64_tr_b16 v[114:115], v140 offset:11520
    v_exp_f32 v39, v15
    v_exp_f32 v40, v16
    s_waitcnt lgkmcnt(11)
    v_exp_f32 v41, v17
    v_smfmac_f32_32x32x32_bf16 v[64:79], v[52:55], v[4:11], v167
    ds_read_b128 v[52:55], v138 offset:2816
    v_exp_f32 v42, v18
    v_exp_f32 v43, v19
    v_add_u32 v143, s74, v143
    v_add_u32 v144, s74, v144
    v_add_u32 v140, s74, v140
    s_waitcnt lgkmcnt(1)
    s_barrier
    s_nop 0
    v_mfma_f32_32x32x16_bf16 v[4:19], v[44:47], v[60:63], 0
    ds_read_b128 v[44:47], v136 offset:8448
    v_exp_f32 v20, v20
    v_exp_f32 v21, v21
    v_smfmac_f32_32x32x32_bf16 v[64:79], v[56:59], v[36:43], v167
    ds_read_b128 v[56:59], v139 offset:2816
    v_exp_f32_e64 v22, v22
    v_mfma_f32_32x32x8_bf16 v[4:19], v[48:49], v[50:51], v[4:19]
    ds_read_b64 v[48:49], v137 offset:8448
    v_exp_f32 v23, v23
    v_exp_f32 v24, v24
    v_mfma_f32_32x32x16_bf16 v[80:95], v[128:131], v[124:127], v[80:95]
    ds_read_b128 v[128:131], v142 offset:0
    v_exp_f32 v25, v25
    v_exp_f32 v26, v26
    v_mfma_f32_32x32x16_bf16 v[96:111], v[120:123], v[112:115], v[96:111]
    ds_read_b128 v[120:123], v141 offset:4096
    v_exp_f32 v27, v27
    v_exp_f32 v36, v28
    v_exp_f32_e64 v37, v29
    v_mfma_f32_32x32x16_bf16 v[96:111], v[132:135], v[124:127], v[96:111]
    ds_read_b128 v[132:135], v142 offset:4096
    ds_read_b64_tr_b16 v[124:125], v140 offset:5120
    ds_read_b64_tr_b16 v[126:127], v140 offset:6400
    v_exp_f32_e64 v38, v30
    v_mfma_f32_32x32x16_bf16 v[80:95], v[116:119], v[112:115], v[80:95]
    ds_read_b128 v[116:119], v141 offset:0
    ds_read_b64_tr_b16 v[112:113], v140 offset:0
    ds_read_b64_tr_b16 v[114:115], v140 offset:1280
    v_exp_f32 v39, v31
    v_exp_f32 v40, v32
    s_waitcnt lgkmcnt(11)
    v_exp_f32 v41, v33
    v_smfmac_f32_32x32x32_bf16 v[64:79], v[52:55], v[20:27], v167
    ds_read_b128 v[52:55], v138 offset:5632
    v_exp_f32 v42, v34
    s_waitcnt lgkmcnt(11)
    v_exp_f32_e64 v43, v35
    v_mfma_f32_32x32x16_bf16 v[20:35], v[44:47], v[60:63], 0
    ds_read_b128 v[44:47], v136 offset:11264
    v_exp_f32 v4, v4
    s_waitcnt lgkmcnt(11)
    v_exp_f32_e64 v5, v5
    v_smfmac_f32_32x32x32_bf16 v[64:79], v[56:59], v[36:43], v167
    ds_read_b128 v[56:59], v139 offset:5632
    s_waitcnt lgkmcnt(11)
    v_exp_f32 v6, v6
    v_mfma_f32_32x32x8_bf16 v[20:35], v[48:49], v[50:51], v[20:35]
    ds_read_b64 v[48:49], v137 offset:11264
    v_exp_f32 v7, v7
    s_waitcnt lgkmcnt(7)
    v_exp_f32_e64 v8, v8
    v_mfma_f32_32x32x16_bf16 v[80:95], v[128:131], v[124:127], v[80:95]
    ds_read_b128 v[128:131], v144 offset:0
    v_exp_f32 v9, v9
    s_waitcnt lgkmcnt(5)
    v_exp_f32_e64 v10, v10
    v_mfma_f32_32x32x16_bf16 v[96:111], v[120:123], v[112:115], v[96:111]
    ds_read_b128 v[120:123], v143 offset:4096
    v_exp_f32 v11, v11
    v_exp_f32 v36, v12
    v_exp_f32_e64 v37, v13
    v_mfma_f32_32x32x16_bf16 v[96:111], v[132:135], v[124:127], v[96:111]
    ds_read_b128 v[132:135], v144 offset:4096
    ds_read_b64_tr_b16 v[124:125], v140 offset:15360
    ds_read_b64_tr_b16 v[126:127], v140 offset:16640
    v_exp_f32_e64 v38, v14
    v_mfma_f32_32x32x16_bf16 v[80:95], v[116:119], v[112:115], v[80:95]
    ds_read_b128 v[116:119], v143 offset:0
    ds_read_b64_tr_b16 v[112:113], v140 offset:10240
    ds_read_b64_tr_b16 v[114:115], v140 offset:11520
    v_exp_f32 v39, v15
    v_exp_f32 v40, v16
    s_waitcnt lgkmcnt(11)
    v_exp_f32 v41, v17
    v_smfmac_f32_32x32x32_bf16 v[64:79], v[52:55], v[4:11], v167
    ds_read_b128 v[52:55], v138 offset:8448
    v_exp_f32 v42, v18
    s_waitcnt lgkmcnt(11)
    v_exp_f32_e64 v43, v19
    v_mfma_f32_32x32x16_bf16 v[4:19], v[44:47], v[60:63], 0
    ds_read_b128 v[44:47], v136 offset:14080
    v_exp_f32 v20, v20
    s_waitcnt lgkmcnt(11)
    v_exp_f32_e64 v21, v21
    v_smfmac_f32_32x32x32_bf16 v[64:79], v[56:59], v[36:43], v167
    ds_read_b128 v[56:59], v139 offset:8448
    s_waitcnt lgkmcnt(11)
    v_exp_f32 v22, v22
    v_mfma_f32_32x32x8_bf16 v[4:19], v[48:49], v[50:51], v[4:19]
    ds_read_b64 v[48:49], v137 offset:14080
    v_exp_f32 v23, v23
    s_waitcnt lgkmcnt(7)
    v_exp_f32_e64 v24, v24
    v_mfma_f32_32x32x16_bf16 v[80:95], v[128:131], v[124:127], v[80:95]
    v_exp_f32 v25, v25
    s_waitcnt lgkmcnt(4)
    v_exp_f32_e64 v26, v26
    v_mfma_f32_32x32x16_bf16 v[96:111], v[120:123], v[112:115], v[96:111]
    v_exp_f32 v27, v27
    v_exp_f32 v36, v28
    v_exp_f32_e64 v37, v29
    v_mfma_f32_32x32x16_bf16 v[96:111], v[132:135], v[124:127], v[96:111]
    v_exp_f32_e64 v38, v30
    v_mfma_f32_32x32x16_bf16 v[80:95], v[116:119], v[112:115], v[80:95]
    v_exp_f32 v39, v31
    v_exp_f32 v40, v32
    s_waitcnt lgkmcnt(3)
    v_exp_f32 v41, v33
    v_smfmac_f32_32x32x32_bf16 v[64:79], v[52:55], v[20:27], v167
    ds_read_b128 v[52:55], v138 offset:11264
    v_exp_f32 v42, v34
    v_exp_f32 v43, v35
    s_mov_b32 s8, 0x3fb8aa3b
    s_mov_b32 s9, 0x358637bd
    s_lshl_b32 s10, s78, 12
    v_add_u32 v162, s10, v146
    s_cmp_eq_u32 s78, 2
    s_cselect_b32 s10, 0xffff, -1
    s_mov_b32 s11, s10
    s_cmp_ge_u32 s78, 3
    s_cbranch_scc1 B_np_1
    s_mov_b64 exec, s[10:11]
    v_pk_mul_f32 v[112:113], v[80:81], s[8:9] op_sel_hi:[1,0]
    v_pk_mul_f32 v[114:115], v[82:83], s[8:9] op_sel_hi:[1,0]
    v_exp_f32_e64 v112, v112 clamp
    v_exp_f32_e64 v113, v113 clamp
    v_exp_f32_e64 v114, v114 clamp
    v_exp_f32_e64 v115, v115 clamp
    v_max_f32 v80, s9, v80
    v_max_f32 v81, s9, v81
    v_max_f32 v82, s9, v82
    v_max_f32 v83, s9, v83
    v_pk_add_f32 v[80:81], v[80:81], v[112:113]
    v_pk_add_f32 v[82:83], v[82:83], v[114:115]
    v_pk_mul_f32 v[116:117], v[84:85], s[8:9] op_sel_hi:[1,0]
    v_pk_mul_f32 v[118:119], v[86:87], s[8:9] op_sel_hi:[1,0]
    v_exp_f32_e64 v116, v116 clamp
    v_exp_f32_e64 v117, v117 clamp
    v_exp_f32_e64 v118, v118 clamp
    v_exp_f32_e64 v119, v119 clamp
    v_max_f32 v84, s9, v84
    v_max_f32 v85, s9, v85
    v_max_f32 v86, s9, v86
    v_max_f32 v87, s9, v87
    v_pk_add_f32 v[84:85], v[84:85], v[116:117]
    v_pk_add_f32 v[86:87], v[86:87], v[118:119]
    s_mov_b64 exec, -1
B_np_1:
    v_cvt_pk_bf16_f32 v80, v80, v81
    v_cvt_pk_bf16_f32 v81, v82, v83
    v_cvt_pk_bf16_f32 v82, v84, v85
    v_cvt_pk_bf16_f32 v83, v86, v87
    ds_write_b128 v162, v[80:83] offset:38912
    s_cbranch_scc1 B_np_2
    s_mov_b64 exec, s[10:11]
    v_pk_mul_f32 v[112:113], v[88:89], s[8:9] op_sel_hi:[1,0]
    v_pk_mul_f32 v[114:115], v[90:91], s[8:9] op_sel_hi:[1,0]
    v_exp_f32_e64 v112, v112 clamp
    v_exp_f32_e64 v113, v113 clamp
    v_exp_f32_e64 v114, v114 clamp
    v_exp_f32_e64 v115, v115 clamp
    v_max_f32 v88, s9, v88
    v_max_f32 v89, s9, v89
    v_max_f32 v90, s9, v90
    v_max_f32 v91, s9, v91
    v_pk_add_f32 v[88:89], v[88:89], v[112:113]
    v_pk_add_f32 v[90:91], v[90:91], v[114:115]
    v_pk_mul_f32 v[116:117], v[92:93], s[8:9] op_sel_hi:[1,0]
    v_pk_mul_f32 v[118:119], v[94:95], s[8:9] op_sel_hi:[1,0]
    v_exp_f32_e64 v116, v116 clamp
    v_exp_f32_e64 v117, v117 clamp
    v_exp_f32_e64 v118, v118 clamp
    v_exp_f32_e64 v119, v119 clamp
    v_max_f32 v92, s9, v92
    v_max_f32 v93, s9, v93
    v_max_f32 v94, s9, v94
    v_max_f32 v95, s9, v95
    v_pk_add_f32 v[92:93], v[92:93], v[116:117]
    v_pk_add_f32 v[94:95], v[94:95], v[118:119]
    s_mov_b64 exec, -1
B_np_2:
    v_cvt_pk_bf16_f32 v88, v88, v89
    v_cvt_pk_bf16_f32 v89, v90, v91
    v_cvt_pk_bf16_f32 v90, v92, v93
    v_cvt_pk_bf16_f32 v91, v94, v95
    ds_write_b128 v162, v[88:91] offset:39936
    s_cbranch_scc1 B_np_3
    s_mov_b64 exec, s[10:11]
    v_pk_mul_f32 v[112:113], v[96:97], s[8:9] op_sel_hi:[1,0]
    v_pk_mul_f32 v[114:115], v[98:99], s[8:9] op_sel_hi:[1,0]
    v_exp_f32_e64 v112, v112 clamp
    v_exp_f32_e64 v113, v113 clamp
    v_exp_f32_e64 v114, v114 clamp
    v_exp_f32_e64 v115, v115 clamp
    v_max_f32 v96, s9, v96
    v_max_f32 v97, s9, v97
    v_max_f32 v98, s9, v98
    v_max_f32 v99, s9, v99
    v_pk_add_f32 v[96:97], v[96:97], v[112:113]
    v_pk_add_f32 v[98:99], v[98:99], v[114:115]
    v_pk_mul_f32 v[116:117], v[100:101], s[8:9] op_sel_hi:[1,0]
    v_pk_mul_f32 v[118:119], v[102:103], s[8:9] op_sel_hi:[1,0]
    v_exp_f32_e64 v116, v116 clamp
    v_exp_f32_e64 v117, v117 clamp
    v_exp_f32_e64 v118, v118 clamp
    v_exp_f32_e64 v119, v119 clamp
    v_max_f32 v100, s9, v100
    v_max_f32 v101, s9, v101
    v_max_f32 v102, s9, v102
    v_max_f32 v103, s9, v103
    v_pk_add_f32 v[100:101], v[100:101], v[116:117]
    v_pk_add_f32 v[102:103], v[102:103], v[118:119]
    s_mov_b64 exec, -1
B_np_3:
    v_cvt_pk_bf16_f32 v96, v96, v97
    v_cvt_pk_bf16_f32 v97, v98, v99
    v_cvt_pk_bf16_f32 v98, v100, v101
    v_cvt_pk_bf16_f32 v99, v102, v103
    ds_write_b128 v162, v[96:99] offset:40960
    s_cbranch_scc1 B_np_4
    s_mov_b64 exec, s[10:11]
    v_pk_mul_f32 v[112:113], v[104:105], s[8:9] op_sel_hi:[1,0]
    v_pk_mul_f32 v[114:115], v[106:107], s[8:9] op_sel_hi:[1,0]
    v_exp_f32_e64 v112, v112 clamp
    v_exp_f32_e64 v113, v113 clamp
    v_exp_f32_e64 v114, v114 clamp
    v_exp_f32_e64 v115, v115 clamp
    v_max_f32 v104, s9, v104
    v_max_f32 v105, s9, v105
    v_max_f32 v106, s9, v106
    v_max_f32 v107, s9, v107
    v_pk_add_f32 v[104:105], v[104:105], v[112:113]
    v_pk_add_f32 v[106:107], v[106:107], v[114:115]
    v_pk_mul_f32 v[116:117], v[108:109], s[8:9] op_sel_hi:[1,0]
    v_pk_mul_f32 v[118:119], v[110:111], s[8:9] op_sel_hi:[1,0]
    v_exp_f32_e64 v116, v116 clamp
    v_exp_f32_e64 v117, v117 clamp
    v_exp_f32_e64 v118, v118 clamp
    v_exp_f32_e64 v119, v119 clamp
    v_max_f32 v108, s9, v108
    v_max_f32 v109, s9, v109
    v_max_f32 v110, s9, v110
    v_max_f32 v111, s9, v111
    v_pk_add_f32 v[108:109], v[108:109], v[116:117]
    v_pk_add_f32 v[110:111], v[110:111], v[118:119]
    s_mov_b64 exec, -1
B_np_4:
    v_cvt_pk_bf16_f32 v104, v104, v105
    v_cvt_pk_bf16_f32 v105, v106, v107
    v_cvt_pk_bf16_f32 v106, v108, v109
    v_cvt_pk_bf16_f32 v107, v110, v111
    ds_write_b128 v162, v[104:107] offset:41984
B_jobs:
    s_waitcnt lgkmcnt(0)
    s_cmp_lg_u32 s52, 0
    s_cbranch_scc1 B_noz
    v_mov_b32 v96, 0x3f803f80
    v_mov_b32 v97, 0x3f803f80
    v_mov_b32 v98, 0x3f803f80
    v_mov_b32 v99, 0x3f803f80
    v_mov_b32 v100, 0x3f803f80
    v_mov_b32 v101, 0x3f803f80
    v_mov_b32 v102, 0x3f803f80
    v_mov_b32 v103, 0x3f803f80
    v_mov_b32 v104, 0x3f803f80
    v_mov_b32 v105, 0x3f803f80
    v_mov_b32 v106, 0x3f803f80
    v_mov_b32 v107, 0x3f803f80
    v_mov_b32 v108, 0x3f803f80
    v_mov_b32 v109, 0x3f803f80
    v_mov_b32 v110, 0x3f803f80
    v_mov_b32 v111, 0x3f803f80
.p2align 3
B_noz:
    s_barrier
    s_nop 0
    v_mfma_f32_32x32x16_bf16 v[20:35], v[44:47], v[60:63], 0
    ds_read_b128 v[44:47], v136 offset:16896
    ds_read_b128 v[80:83], v151 offset:38912
    ds_read_b128 v[84:87], v151 offset:39936
    ds_read_b128 v[88:91], v151 offset:40960
    ds_read_b128 v[92:95], v151 offset:41984
    s_mov_b64 exec, s[52:53]
    s_nop 0
    ds_read_b128 v[96:99], v152 offset:38912
    ds_read_b128 v[100:103], v152 offset:39936
    ds_read_b128 v[104:107], v152 offset:40960
    ds_read_b128 v[108:111], v152 offset:41984
    s_mov_b64 exec, -1
    s_nop 0
    ds_read_b128 v[128:131], v154
    ds_read_b64 v[132:133], v153
    v_exp_f32 v4, v4
    v_exp_f32 v5, v5
    v_exp_f32 v6, v6
    v_exp_f32 v7, v7
    v_mfma_f32_32x32x8_bf16 v[20:35], v[48:49], v[50:51], v[20:35]
    ds_read_b64 v[48:49], v137 offset:16896
    v_exp_f32 v8, v8
    v_exp_f32 v9, v9
    v_exp_f32 v10, v10
    v_exp_f32 v11, v11
    v_smfmac_f32_32x32x32_bf16 v[64:79], v[56:59], v[36:43], v167
    ds_read_b128 v[56:59], v139 offset:11264
    v_exp_f32 v36, v12
    s_waitcnt lgkmcnt(4)
    v_exp_f32_e64 v37, v13
    v_mfma_f32_32x32x16_bf16 v[112:127], v[80:83], v[96:99], 0
    v_exp_f32 v38, v14
    v_exp_f32 v39, v15
    v_mfma_f32_32x32x16_bf16 v[112:127], v[84:87], v[100:103], v[112:127]
    v_smfmac_f32_32x32x32_bf16 v[64:79], v[52:55], v[4:11], v167
    ds_read_b128 v[52:55], v138 offset:14080
    v_exp_f32 v40, v16
    v_exp_f32 v41, v17
    v_mfma_f32_32x32x16_bf16 v[112:127], v[88:91], v[104:107], v[112:127]
    v_exp_f32 v42, v18
    v_exp_f32 v43, v19
    v_mfma_f32_32x32x16_bf16 v[112:127], v[92:95], v[108:111], v[112:127]
    v_mfma_f32_32x32x16_bf16 v[4:19], v[44:47], v[60:63], 0
    ds_read_b128 v[44:47], v136 offset:19712
    s_waitcnt lgkmcnt(4)
    s_mov_b32 exec_lo, 0
    v_mov_b32 v132, 0
    v_mov_b32 v133, 0
    s_mov_b32 exec_lo, -1
    v_exp_f32 v20, v20
    v_exp_f32 v21, v21
    v_exp_f32 v22, v22
    s_waitcnt lgkmcnt(3)
    v_exp_f32 v23, v23
    v_mfma_f32_32x32x8_bf16 v[4:19], v[48:49], v[50:51], v[4:19]
    ds_read_b64 v[48:49], v137 offset:19712
    v_exp_f32 v24, v24
    v_exp_f32 v25, v25
    s_mov_b64 exec, s[92:93]
    s_nop 0
    ds_write_b128 v147, v[112:115]
    s_mov_b64 exec, s[94:95]
    s_nop 0
    ds_write_b128 v148, v[116:119]
    s_mov_b64 exec, -1
    v_exp_f32 v26, v26
    s_waitcnt lgkmcnt(5)
    v_exp_f32 v27, v27
    v_smfmac_f32_32x32x32_bf16 v[64:79], v[56:59], v[36:43], v167
    ds_read_b128 v[56:59], v139 offset:14080
    s_mov_b64 exec, s[98:99]
    s_nop 0
    ds_write_b128 v149, v[120:123]
    s_mov_b64 exec, s[100:101]
    s_nop 0
    ds_write_b128 v150, v[124:127]
    s_mov_b64 exec, -1
    v_exp_f32 v36, v28
    v_exp_f32 v37, v29
    v_exp_f32 v38, v30
    s_waitcnt lgkmcnt(7)
    v_exp_f32 v39, v31
    v_smfmac_f32_32x32x32_bf16 v[64:79], v[52:55], v[20:27], v167
    ds_read_b128 v[52:55], v138 offset:16896
    v_exp_f32 v40, v32
    v_exp_f32 v41, v33
    v_exp_f32 v42, v34
    s_waitcnt lgkmcnt(1)
    v_exp_f32 v43, v35
    s_barrier
    v_mfma_f32_32x32x16_bf16 v[20:35], v[44:47], v[60:63], 0
    ds_read_b128 v[44:47], v136 offset:22528
    v_exp_f32 v4, v4
    v_exp_f32 v5, v5
    v_exp_f32 v6, v6
    v_exp_f32 v7, v7
    v_mfma_f32_32x32x8_bf16 v[20:35], v[48:49], v[50:51], v[20:35]
    ds_read_b64 v[48:49], v137 offset:22528
    v_exp_f32 v8, v8
    v_exp_f32 v9, v9
    v_exp_f32 v10, v10
    v_exp_f32 v11, v11
    v_smfmac_f32_32x32x32_bf16 v[64:79], v[56:59], v[36:43], v167
    ds_read_b128 v[56:59], v139 offset:16896
    v_exp_f32 v36, v12
    v_exp_f32 v37, v13
    v_exp_f32 v38, v14
    s_waitcnt lgkmcnt(3)
    v_exp_f32_e64 v39, v15
    v_smfmac_f32_32x32x32_bf16 v[64:79], v[52:55], v[4:11], v167
    ds_read_b128 v[52:55], v138 offset:19712
    v_exp_f32 v40, v16
    v_exp_f32 v41, v17
    v_exp_f32 v42, v18
    s_waitcnt lgkmcnt(3)
    v_exp_f32_e64 v43, v19
    v_mfma_f32_32x32x16_bf16 v[4:19], v[44:47], v[60:63], 0
    ds_read_b128 v[44:47], v136 offset:25344
    v_exp_f32 v20, v20
    v_exp_f32 v21, v21
    v_exp_f32 v22, v22
    s_waitcnt lgkmcnt(3)
    v_exp_f32_e64 v23, v23
    v_mfma_f32_32x32x8_bf16 v[4:19], v[48:49], v[50:51], v[4:19]
    ds_read_b64 v[48:49], v137 offset:25344
    v_exp_f32 v24, v24
    v_exp_f32 v25, v25
    v_exp_f32 v26, v26
    s_waitcnt lgkmcnt(3)
    v_exp_f32_e64 v27, v27
    v_smfmac_f32_32x32x32_bf16 v[64:79], v[56:59], v[36:43], v167
    ds_read_b128 v[56:59], v139 offset:19712
    v_exp_f32 v36, v28
    v_exp_f32 v37, v29
    v_exp_f32 v38, v30
    s_waitcnt lgkmcnt(3)
    v_exp_f32_e64 v39, v31
    v_smfmac_f32_32x32x32_bf16 v[64:79], v[52:55], v[20:27], v167
    ds_read_b128 v[52:55], v138 offset:22528
    v_exp_f32 v40, v32
    v_exp_f32 v41, v33
    v_exp_f32 v42, v34
    s_waitcnt lgkmcnt(3)
    v_exp_f32_e64 v43, v35
    v_mfma_f32_32x32x16_bf16 v[20:35], v[44:47], v[60:63], 0
    ds_read_b128 v[44:47], v136 offset:28160
    v_exp_f32 v4, v4
    v_exp_f32 v5, v5
    v_exp_f32 v6, v6
    s_waitcnt lgkmcnt(3)
    v_exp_f32_e64 v7, v7
    v_mfma_f32_32x32x8_bf16 v[20:35], v[48:49], v[50:51], v[20:35]
    ds_read_b64 v[48:49], v137 offset:28160
    v_exp_f32 v8, v8
    v_exp_f32 v9, v9
    v_exp_f32 v10, v10
    s_waitcnt lgkmcnt(3)
    v_exp_f32_e64 v11, v11
    v_smfmac_f32_32x32x32_bf16 v[64:79], v[56:59], v[36:43], v167
    ds_read_b128 v[56:59], v139 offset:22528
    v_exp_f32 v36, v12
    v_exp_f32 v37, v13
    v_exp_f32 v38, v14
    s_waitcnt lgkmcnt(3)
    v_exp_f32_e64 v39, v15
    v_smfmac_f32_32x32x32_bf16 v[64:79], v[52:55], v[4:11], v167
    ds_read_b128 v[52:55], v138 offset:25344
    v_exp_f32 v40, v16
    v_exp_f32 v41, v17
    v_exp_f32 v42, v18
    s_waitcnt lgkmcnt(3)
    v_exp_f32_e64 v43, v19
    v_mfma_f32_32x32x16_bf16 v[4:19], v[44:47], v[60:63], 0
    ds_read_b128 v[44:47], v136 offset:30976
    v_exp_f32 v20, v20
    v_exp_f32 v21, v21
    v_exp_f32 v22, v22
    s_waitcnt lgkmcnt(3)
    v_exp_f32_e64 v23, v23
    v_mfma_f32_32x32x8_bf16 v[4:19], v[48:49], v[50:51], v[4:19]
    ds_read_b64 v[48:49], v137 offset:30976
    v_exp_f32 v24, v24
    v_exp_f32 v25, v25
    v_exp_f32 v26, v26
    s_waitcnt lgkmcnt(3)
    v_exp_f32_e64 v27, v27
    v_smfmac_f32_32x32x32_bf16 v[64:79], v[56:59], v[36:43], v167
    ds_read_b128 v[56:59], v139 offset:25344
    v_exp_f32 v36, v28
    v_exp_f32 v37, v29
    v_exp_f32 v38, v30
    s_waitcnt lgkmcnt(3)
    v_exp_f32_e64 v39, v31
    v_smfmac_f32_32x32x32_bf16 v[64:79], v[52:55], v[20:27], v167
    ds_read_b128 v[52:55], v138 offset:28160
    v_exp_f32 v40, v32
    v_exp_f32 v41, v33
    v_exp_f32 v42, v34
    s_waitcnt lgkmcnt(3)
    v_exp_f32_e64 v43, v35
    v_mfma_f32_32x32x16_bf16 v[20:35], v[44:47], v[60:63], 0
    ds_read_b128 v[44:47], v136 offset:33792
    v_exp_f32 v4, v4
    v_exp_f32 v5, v5
    v_exp_f32 v6, v6
    s_waitcnt lgkmcnt(3)
    v_exp_f32_e64 v7, v7
    v_mfma_f32_32x32x8_bf16 v[20:35], v[48:49], v[50:51], v[20:35]
    ds_read_b64 v[48:49], v137 offset:33792
    v_exp_f32 v8, v8
    v_exp_f32 v9, v9
    v_exp_f32 v10, v10
    s_waitcnt lgkmcnt(3)
    v_exp_f32_e64 v11, v11
    v_smfmac_f32_32x32x32_bf16 v[64:79], v[56:59], v[36:43], v167
    ds_read_b128 v[56:59], v139 offset:28160
    v_exp_f32 v36, v12
    v_exp_f32 v37, v13
    v_exp_f32 v38, v14
    s_waitcnt lgkmcnt(3)
    v_exp_f32_e64 v39, v15
    v_smfmac_f32_32x32x32_bf16 v[64:79], v[52:55], v[4:11], v167
    ds_read_b128 v[52:55], v138 offset:30976
    v_exp_f32 v40, v16
    v_exp_f32 v41, v17
    v_exp_f32 v42, v18
    s_waitcnt lgkmcnt(3)
    v_exp_f32 v43, v19
    s_barrier
    v_mfma_f32_32x32x16_bf16 v[4:19], v[44:47], v[60:63], 0
    ds_read_b128 v[44:47], v136 offset:36608
    v_exp_f32 v20, v20
    v_exp_f32 v21, v21
    v_exp_f32 v22, v22
    s_waitcnt lgkmcnt(3)
    v_exp_f32_e64 v23, v23
    v_mfma_f32_32x32x8_bf16 v[4:19], v[48:49], v[50:51], v[4:19]
    ds_read_b64 v[48:49], v137 offset:36608
    v_exp_f32 v24, v24
    v_exp_f32 v25, v25
    v_exp_f32 v26, v26
    s_waitcnt lgkmcnt(3)
    v_exp_f32_e64 v27, v27
    v_smfmac_f32_32x32x32_bf16 v[64:79], v[56:59], v[36:43], v167
    ds_read_b128 v[56:59], v139 offset:30976
    v_exp_f32 v36, v28
    v_exp_f32 v37, v29
    v_exp_f32 v38, v30
    s_waitcnt lgkmcnt(3)
    v_exp_f32_e64 v39, v31
    v_smfmac_f32_32x32x32_bf16 v[64:79], v[52:55], v[20:27], v167
    ds_read_b128 v[52:55], v138 offset:33792
    v_exp_f32 v40, v32
    v_exp_f32 v41, v33
    v_exp_f32 v42, v34
    s_waitcnt lgkmcnt(3)
    v_exp_f32_e64 v43, v35
    v_mfma_f32_32x32x16_bf16 v[20:35], v[44:47], v[60:63], 0
    ds_read_b128 v[44:47], v136 offset:39424
    v_exp_f32 v4, v4
    v_exp_f32 v5, v5
    v_exp_f32 v6, v6
    s_waitcnt lgkmcnt(3)
    v_exp_f32_e64 v7, v7
    v_mfma_f32_32x32x8_bf16 v[20:35], v[48:49], v[50:51], v[20:35]
    ds_read_b64 v[48:49], v137 offset:39424
    v_exp_f32 v8, v8
    v_exp_f32 v9, v9
    v_exp_f32 v10, v10
    s_waitcnt lgkmcnt(3)
    v_exp_f32_e64 v11, v11
    v_smfmac_f32_32x32x32_bf16 v[64:79], v[56:59], v[36:43], v167
    ds_read_b128 v[56:59], v139 offset:33792
    v_exp_f32 v36, v12
    v_exp_f32 v37, v13
    v_exp_f32 v38, v14
    s_waitcnt lgkmcnt(3)
    v_exp_f32_e64 v39, v15
    v_smfmac_f32_32x32x32_bf16 v[64:79], v[52:55], v[4:11], v167
    ds_read_b128 v[52:55], v138 offset:36608
    v_exp_f32 v40, v16
    v_exp_f32 v41, v17
    v_exp_f32 v42, v18
    s_waitcnt lgkmcnt(3)
    v_exp_f32_e64 v43, v19
    v_mfma_f32_32x32x16_bf16 v[4:19], v[44:47], v[60:63], 0
    ds_read_b128 v[44:47], v136 offset:42240
    v_exp_f32 v20, v20
    v_exp_f32 v21, v21
    v_exp_f32 v22, v22
    s_waitcnt lgkmcnt(3)
    v_exp_f32_e64 v23, v23
    v_mfma_f32_32x32x8_bf16 v[4:19], v[48:49], v[50:51], v[4:19]
    ds_read_b64 v[48:49], v137 offset:42240
    v_exp_f32 v24, v24
    v_exp_f32 v25, v25
    v_exp_f32 v26, v26
    s_waitcnt lgkmcnt(3)
    v_exp_f32_e64 v27, v27
    v_smfmac_f32_32x32x32_bf16 v[64:79], v[56:59], v[36:43], v167
    ds_read_b128 v[56:59], v139 offset:36608
    v_exp_f32 v36, v28
    v_exp_f32 v37, v29
    v_exp_f32 v38, v30
    s_waitcnt lgkmcnt(3)
    v_exp_f32_e64 v39, v31
    v_smfmac_f32_32x32x32_bf16 v[64:79], v[52:55], v[20:27], v167
    ds_read_b128 v[52:55], v138 offset:39424
    v_exp_f32 v40, v32
    v_exp_f32 v41, v33
    v_exp_f32 v42, v34
    s_waitcnt lgkmcnt(3)
    v_exp_f32_e64 v43, v35
    v_mfma_f32_32x32x16_bf16 v[20:35], v[44:47], v[60:63], 0
    ds_read_b128 v[44:47], v136 offset:0
    v_exp_f32 v4, v4
    v_exp_f32 v5, v5
    v_exp_f32 v6, v6
    s_waitcnt lgkmcnt(3)
    v_exp_f32_e64 v7, v7
    v_mfma_f32_32x32x8_bf16 v[20:35], v[48:49], v[50:51], v[20:35]
    ds_read_b64 v[48:49], v137 offset:0
    v_exp_f32 v8, v8
    v_exp_f32 v9, v9
    v_exp_f32 v10, v10
    s_waitcnt lgkmcnt(3)
    v_exp_f32_e64 v11, v11
    v_smfmac_f32_32x32x32_bf16 v[64:79], v[56:59], v[36:43], v167
    ds_read_b128 v[56:59], v139 offset:39424
    v_exp_f32 v36, v12
    v_exp_f32 v37, v13
    v_exp_f32 v38, v14
    s_waitcnt lgkmcnt(3)
    v_exp_f32_e64 v39, v15
    v_smfmac_f32_32x32x32_bf16 v[64:79], v[52:55], v[4:11], v167
    ds_read_b128 v[52:55], v138 offset:42240
    v_exp_f32 v40, v16
    v_exp_f32 v41, v17
    v_exp_f32 v42, v18
    s_waitcnt lgkmcnt(3)
    v_exp_f32_e64 v43, v19
    v_mfma_f32_32x32x16_bf16 v[4:19], v[44:47], v[60:63], 0
    ds_read_b128 v[44:47], v136 offset:2816
    v_exp_f32 v20, v20
    v_exp_f32 v21, v21
    v_exp_f32 v22, v22
    s_waitcnt lgkmcnt(3)
    v_exp_f32_e64 v23, v23
    v_mfma_f32_32x32x8_bf16 v[4:19], v[48:49], v[50:51], v[4:19]
    ds_read_b64 v[48:49], v137 offset:2816
    v_exp_f32 v24, v24
    v_exp_f32 v25, v25
    v_exp_f32 v26, v26
    s_waitcnt lgkmcnt(3)
    v_exp_f32_e64 v27, v27
    v_smfmac_f32_32x32x32_bf16 v[64:79], v[56:59], v[36:43], v167
    ds_read_b128 v[56:59], v139 offset:42240
    v_exp_f32 v36, v28
    v_exp_f32 v37, v29
    v_exp_f32 v38, v30
    s_waitcnt lgkmcnt(3)
    v_exp_f32_e64 v39, v31
    v_smfmac_f32_32x32x32_bf16 v[64:79], v[52:55], v[20:27], v167
    ds_read_b128 v[52:55], v138 offset:0
    v_exp_f32 v40, v32
    v_exp_f32 v41, v33
    v_exp_f32 v42, v34
    s_waitcnt lgkmcnt(3)
    v_exp_f32 v43, v35
    s_barrier
    v_mfma_f32_32x32x16_bf16 v[20:35], v[44:47], v[60:63], 0
    ds_read_b128 v[44:47], v136 offset:5632
    v_exp_f32 v4, v4
    v_exp_f32 v5, v5
    v_exp_f32 v6, v6
    s_waitcnt lgkmcnt(3)
    v_exp_f32_e64 v7, v7
    v_mfma_f32_32x32x8_bf16 v[20:35], v[48:49], v[50:51], v[20:35]
    ds_read_b64 v[48:49], v137 offset:5632
    v_exp_f32 v8, v8
    v_exp_f32 v9, v9
    v_exp_f32 v10, v10
    s_waitcnt lgkmcnt(3)
    v_exp_f32_e64 v11, v11
    v_smfmac_f32_32x32x32_bf16 v[64:79], v[56:59], v[36:43], v167
    ds_read_b128 v[56:59], v139 offset:0
    v_exp_f32 v36, v12
    v_exp_f32 v37, v13
    v_exp_f32 v38, v14
    s_waitcnt lgkmcnt(3)
    v_exp_f32_e64 v39, v15
    v_smfmac_f32_32x32x32_bf16 v[64:79], v[52:55], v[4:11], v167
    ds_read_b128 v[52:55], v138 offset:2816
    v_exp_f32 v40, v16
    v_exp_f32 v41, v17
    v_exp_f32 v42, v18
    s_waitcnt lgkmcnt(3)
    v_exp_f32_e64 v43, v19
    v_mfma_f32_32x32x16_bf16 v[4:19], v[44:47], v[60:63], 0
    ds_read_b128 v[44:47], v136 offset:8448
    v_exp_f32 v20, v20
    v_exp_f32 v21, v21
    v_exp_f32 v22, v22
    s_waitcnt lgkmcnt(3)
    v_exp_f32_e64 v23, v23
    v_mfma_f32_32x32x8_bf16 v[4:19], v[48:49], v[50:51], v[4:19]
    ds_read_b64 v[48:49], v137 offset:8448
    v_exp_f32 v24, v24
    v_exp_f32 v25, v25
    v_exp_f32 v26, v26
    s_waitcnt lgkmcnt(3)
    v_exp_f32_e64 v27, v27
    v_smfmac_f32_32x32x32_bf16 v[64:79], v[56:59], v[36:43], v167
    ds_read_b128 v[56:59], v139 offset:2816
    v_exp_f32 v36, v28
    v_exp_f32 v37, v29
    v_exp_f32 v38, v30
    s_waitcnt lgkmcnt(3)
    v_exp_f32_e64 v39, v31
    v_smfmac_f32_32x32x32_bf16 v[64:79], v[52:55], v[20:27], v167
    ds_read_b128 v[52:55], v138 offset:5632
    v_exp_f32 v40, v32
    v_exp_f32 v41, v33
    v_exp_f32 v42, v34
    s_waitcnt lgkmcnt(3)
    v_exp_f32_e64 v43, v35
    v_mfma_f32_32x32x16_bf16 v[20:35], v[44:47], v[60:63], 0
    ds_read_b128 v[44:47], v136 offset:11264
    v_exp_f32 v4, v4
    v_exp_f32 v5, v5
    v_exp_f32 v6, v6
    s_waitcnt lgkmcnt(3)
    v_exp_f32_e64 v7, v7
    v_mfma_f32_32x32x8_bf16 v[20:35], v[48:49], v[50:51], v[20:35]
    ds_read_b64 v[48:49], v137 offset:11264
    v_exp_f32 v8, v8
    v_exp_f32 v9, v9
    v_exp_f32 v10, v10
    s_waitcnt lgkmcnt(3)
    v_exp_f32_e64 v11, v11
    v_smfmac_f32_32x32x32_bf16 v[64:79], v[56:59], v[36:43], v167
    ds_read_b128 v[56:59], v139 offset:5632
    v_exp_f32 v36, v12
    v_exp_f32 v37, v13
    v_exp_f32 v38, v14
    s_waitcnt lgkmcnt(3)
    v_exp_f32_e64 v39, v15
    v_smfmac_f32_32x32x32_bf16 v[64:79], v[52:55], v[4:11], v167
    ds_read_b128 v[52:55], v138 offset:8448
    v_exp_f32 v40, v16
    v_exp_f32 v41, v17
    v_exp_f32 v42, v18
    s_waitcnt lgkmcnt(3)
    v_exp_f32_e64 v43, v19
    v_mfma_f32_32x32x16_bf16 v[4:19], v[44:47], v[60:63], 0
    ds_read_b128 v[44:47], v136 offset:14080
    v_exp_f32 v20, v20
    v_exp_f32 v21, v21
    v_exp_f32 v22, v22
    s_waitcnt lgkmcnt(3)
    v_exp_f32_e64 v23, v23
    v_mfma_f32_32x32x8_bf16 v[4:19], v[48:49], v[50:51], v[4:19]
    ds_read_b64 v[48:49], v137 offset:14080
    v_exp_f32 v24, v24
    v_exp_f32 v25, v25
    v_exp_f32 v26, v26
    s_waitcnt lgkmcnt(3)
    v_exp_f32_e64 v27, v27
    v_smfmac_f32_32x32x32_bf16 v[64:79], v[56:59], v[36:43], v167
    ds_read_b128 v[56:59], v139 offset:8448
    v_exp_f32 v36, v28
    v_exp_f32 v37, v29
    v_exp_f32 v38, v30
    s_waitcnt lgkmcnt(3)
    v_exp_f32_e64 v39, v31
    v_smfmac_f32_32x32x32_bf16 v[64:79], v[52:55], v[20:27], v167
    ds_read_b128 v[52:55], v138 offset:11264
    v_exp_f32 v40, v32
    v_exp_f32 v41, v33
    v_exp_f32 v42, v34
    s_waitcnt lgkmcnt(3)
    v_exp_f32_e64 v43, v35
    v_mfma_f32_32x32x16_bf16 v[20:35], v[44:47], v[60:63], 0
    ds_read_b128 v[44:47], v136 offset:16896
    v_exp_f32 v4, v4
    v_exp_f32 v5, v5
    v_exp_f32 v6, v6
    s_waitcnt lgkmcnt(3)
    v_exp_f32_e64 v7, v7
    v_mfma_f32_32x32x8_bf16 v[20:35], v[48:49], v[50:51], v[20:35]
    ds_read_b64 v[48:49], v137 offset:16896
    v_exp_f32 v8, v8
    v_exp_f32 v9, v9
    v_exp_f32 v10, v10
    s_waitcnt lgkmcnt(3)
    v_exp_f32_e64 v11, v11
    v_smfmac_f32_32x32x32_bf16 v[64:79], v[56:59], v[36:43], v167
    ds_read_b128 v[56:59], v139 offset:11264
    v_exp_f32 v36, v12
    v_exp_f32 v37, v13
    v_exp_f32 v38, v14
    s_waitcnt lgkmcnt(3)
    v_exp_f32_e64 v39, v15
    v_smfmac_f32_32x32x32_bf16 v[64:79], v[52:55], v[4:11], v167
    ds_read_b128 v[52:55], v138 offset:14080
    v_exp_f32 v40, v16
    v_exp_f32 v41, v17
    v_exp_f32 v42, v18
    s_waitcnt lgkmcnt(3)
    v_exp_f32 v43, v19
    s_barrier
    v_mfma_f32_32x32x16_bf16 v[4:19], v[44:47], v[60:63], 0
    ds_read_b128 v[44:47], v136 offset:19712
    ds_read2_b64 v[100:103], v156 offset0:0 offset1:1
    ds_read_b64 v[104:105], v155 offset:32
    v_exp_f32 v20, v20
    v_exp_f32 v21, v21
    v_exp_f32 v22, v22
    s_waitcnt lgkmcnt(5)
    v_exp_f32_e64 v23, v23
    v_mfma_f32_32x32x8_bf16 v[4:19], v[48:49], v[50:51], v[4:19]
    ds_read_b64 v[48:49], v137 offset:19712
    v_exp_f32 v24, v24
    v_exp_f32 v25, v25
    v_exp_f32 v26, v26
    s_waitcnt lgkmcnt(5)
    v_exp_f32_e64 v27, v27
    v_smfmac_f32_32x32x32_bf16 v[64:79], v[56:59], v[36:43], v167
    ds_read_b128 v[56:59], v139 offset:14080
    v_exp_f32 v36, v28
    s_waitcnt lgkmcnt(2)
    v_exp_f32_e64 v37, v29
    v_mfma_f32_32x32x16_bf16 v[80:95], v[100:103], v[128:131], 0
    v_exp_f32 v38, v30
    v_exp_f32 v39, v31
    v_smfmac_f32_32x32x32_bf16 v[64:79], v[52:55], v[20:27], v167
    ds_read_b128 v[52:55], v138 offset:16896
    v_exp_f32 v40, v32
    v_exp_f32 v41, v33
    v_mfma_f32_32x32x8_bf16 v[80:95], v[104:105], v[132:133], v[80:95]
    v_exp_f32 v42, v34
    v_exp_f32 v43, v35
    v_mfma_f32_32x32x16_bf16 v[20:35], v[44:47], v[60:63], 0
    ds_read_b128 v[44:47], v136 offset:22528
    v_exp_f32 v4, v4
    v_exp_f32 v5, v5
    v_exp_f32 v6, v6
    s_waitcnt lgkmcnt(3)
    v_exp_f32_e64 v7, v7
    v_mfma_f32_32x32x8_bf16 v[20:35], v[48:49], v[50:51], v[20:35]
    ds_read_b64 v[48:49], v137 offset:22528
    v_exp_f32 v8, v8
    v_exp_f32 v9, v9
    v_add_f32 v92, 0x358637bd, v92
    v_rcp_f32 v92, v92
    s_add_u32 s8, s81, 2621440
    s_add_u32 s9, s82, 2621440
    v_pk_mul_f32 v[80:81], v[80:81], v[92:93] op_sel_hi:[1,0]
    v_pk_mul_f32 v[82:83], v[82:83], v[92:93] op_sel_hi:[1,0]
    v_pk_mul_f32 v[84:85], v[84:85], v[92:93] op_sel_hi:[1,0]
    v_pk_mul_f32 v[86:87], v[86:87], v[92:93] op_sel_hi:[1,0]
    v_pk_mul_f32 v[88:89], v[88:89], v[92:93] op_sel_hi:[1,0]
    v_pk_mul_f32 v[90:91], v[90:91], v[92:93] op_sel_hi:[1,0]
    v_cvt_pk_bf16_f32 v80, v80, v81
    v_cvt_pk_bf16_f32 v81, v82, v83
    v_cvt_pk_bf16_f32 v82, v84, v85
    v_cvt_pk_bf16_f32 v83, v86, v87
    v_cvt_pk_bf16_f32 v84, v88, v89
    v_cvt_pk_bf16_f32 v85, v90, v91
    buffer_store_dwordx4 v[80:83], v146, s[40:43], s8 offen sc1
    s_mov_b32 exec_hi, 0
    buffer_store_dwordx2 v[84:85], v145, s[40:43], s9 offen sc1
    s_mov_b32 exec_hi, -1
    v_mov_b32 v100, 163832
    v_mov_b32 v101, 1
    s_mov_b64 exec, 1
.p2align 3
    ds_add_u32 v100, v101
    s_mov_b64 exec, -1
    v_exp_f32 v10, v10
    s_waitcnt lgkmcnt(4)
    v_exp_f32 v11, v11
    v_smfmac_f32_32x32x32_bf16 v[64:79], v[56:59], v[36:43], v167
    ds_read_b128 v[56:59], v139 offset:16896
    v_exp_f32 v36, v12
    v_exp_f32 v37, v13
    v_exp_f32 v38, v14
    s_waitcnt lgkmcnt(4)
    v_exp_f32_e64 v39, v15
    v_smfmac_f32_32x32x32_bf16 v[64:79], v[52:55], v[4:11], v167
    ds_read_b128 v[52:55], v138 offset:19712
    v_exp_f32 v40, v16
    v_exp_f32 v41, v17
    v_exp_f32 v42, v18
    s_waitcnt lgkmcnt(4)
    v_exp_f32_e64 v43, v19
    v_mfma_f32_32x32x16_bf16 v[4:19], v[44:47], v[60:63], 0
    ds_read_b128 v[44:47], v136 offset:25344
    v_exp_f32 v20, v20
    v_exp_f32 v21, v21
    v_exp_f32 v22, v22
    s_waitcnt lgkmcnt(4)
    v_exp_f32_e64 v23, v23
    v_mfma_f32_32x32x8_bf16 v[4:19], v[48:49], v[50:51], v[4:19]
    ds_read_b64 v[48:49], v137 offset:25344
    v_exp_f32 v24, v24
    v_exp_f32 v25, v25
    v_exp_f32 v26, v26
    s_waitcnt lgkmcnt(3)
    v_exp_f32_e64 v27, v27
    v_smfmac_f32_32x32x32_bf16 v[64:79], v[56:59], v[36:43], v167
    ds_read_b128 v[56:59], v139 offset:19712
    v_exp_f32 v36, v28
    v_exp_f32 v37, v29
    v_exp_f32 v38, v30
    s_waitcnt lgkmcnt(3)
    v_exp_f32_e64 v39, v31
    v_smfmac_f32_32x32x32_bf16 v[64:79], v[52:55], v[20:27], v167
    ds_read_b128 v[52:55], v138 offset:22528
    v_exp_f32 v40, v32
    v_exp_f32 v41, v33
    v_exp_f32 v42, v34
    s_waitcnt lgkmcnt(3)
    v_exp_f32_e64 v43, v35
    v_mfma_f32_32x32x16_bf16 v[20:35], v[44:47], v[60:63], 0
    ds_read_b128 v[44:47], v136 offset:28160
    v_exp_f32 v4, v4
    v_exp_f32 v5, v5
    v_exp_f32 v6, v6
    s_waitcnt lgkmcnt(3)
    v_exp_f32_e64 v7, v7
    v_mfma_f32_32x32x8_bf16 v[20:35], v[48:49], v[50:51], v[20:35]
    ds_read_b64 v[48:49], v137 offset:28160
    v_exp_f32 v8, v8
    v_exp_f32 v9, v9
    v_exp_f32 v10, v10
    s_waitcnt lgkmcnt(3)
    v_exp_f32_e64 v11, v11
    v_smfmac_f32_32x32x32_bf16 v[64:79], v[56:59], v[36:43], v167
    ds_read_b128 v[56:59], v139 offset:22528
    v_exp_f32 v36, v12
    v_exp_f32 v37, v13
    v_exp_f32 v38, v14
    s_waitcnt lgkmcnt(3)
    v_exp_f32_e64 v39, v15
    v_smfmac_f32_32x32x32_bf16 v[64:79], v[52:55], v[4:11], v167
    ds_read_b128 v[52:55], v138 offset:25344
    v_exp_f32 v40, v16
    v_exp_f32 v41, v17
    v_exp_f32 v42, v18
    s_waitcnt lgkmcnt(3)
    v_exp_f32_e64 v43, v19
    v_mfma_f32_32x32x16_bf16 v[4:19], v[44:47], v[60:63], 0
    ds_read_b128 v[44:47], v136 offset:30976
    v_exp_f32 v20, v20
    v_exp_f32 v21, v21
    v_exp_f32 v22, v22
    s_waitcnt lgkmcnt(3)
    v_exp_f32_e64 v23, v23
    v_mfma_f32_32x32x8_bf16 v[4:19], v[48:49], v[50:51], v[4:19]
    ds_read_b64 v[48:49], v137 offset:30976
    v_exp_f32 v24, v24
    v_exp_f32 v25, v25
    v_exp_f32 v26, v26
    s_waitcnt lgkmcnt(3)
    v_exp_f32_e64 v27, v27
    v_smfmac_f32_32x32x32_bf16 v[64:79], v[56:59], v[36:43], v167
    ds_read_b128 v[56:59], v139 offset:25344
    v_exp_f32 v36, v28
    v_exp_f32 v37, v29
    v_exp_f32 v38, v30
    s_waitcnt lgkmcnt(3)
    v_exp_f32_e64 v39, v31
    v_smfmac_f32_32x32x32_bf16 v[64:79], v[52:55], v[20:27], v167
    ds_read_b128 v[52:55], v138 offset:28160
    v_exp_f32 v40, v32
    v_exp_f32 v41, v33
    v_exp_f32 v42, v34
    s_waitcnt lgkmcnt(3)
    v_exp_f32 v43, v35
    s_barrier
    v_mfma_f32_32x32x16_bf16 v[20:35], v[44:47], v[60:63], 0
    ds_read_b128 v[44:47], v136 offset:33792
    v_exp_f32 v4, v4
    v_exp_f32 v5, v5
    v_exp_f32 v6, v6
    s_waitcnt lgkmcnt(3)
    v_exp_f32_e64 v7, v7
    v_mfma_f32_32x32x8_bf16 v[20:35], v[48:49], v[50:51], v[20:35]
    ds_read_b64 v[48:49], v137 offset:33792
    v_exp_f32 v8, v8
    v_exp_f32 v9, v9
    v_exp_f32 v10, v10
    s_waitcnt lgkmcnt(3)
    v_exp_f32_e64 v11, v11
    v_smfmac_f32_32x32x32_bf16 v[64:79], v[56:59], v[36:43], v167
    ds_read_b128 v[56:59], v139 offset:28160
    v_exp_f32 v36, v12
    v_exp_f32 v37, v13
    v_exp_f32 v38, v14
    s_waitcnt lgkmcnt(3)
    v_exp_f32_e64 v39, v15
    v_smfmac_f32_32x32x32_bf16 v[64:79], v[52:55], v[4:11], v167
    ds_read_b128 v[52:55], v138 offset:30976
    v_exp_f32 v40, v16
    v_exp_f32 v41, v17
    v_exp_f32 v42, v18
    s_waitcnt lgkmcnt(3)
    v_exp_f32_e64 v43, v19
    v_mfma_f32_32x32x16_bf16 v[4:19], v[44:47], v[60:63], 0
    ds_read_b128 v[44:47], v136 offset:36608
    v_exp_f32 v20, v20
    v_exp_f32 v21, v21
    v_exp_f32 v22, v22
    s_waitcnt lgkmcnt(3)
    v_exp_f32_e64 v23, v23
    v_mfma_f32_32x32x8_bf16 v[4:19], v[48:49], v[50:51], v[4:19]
    ds_read_b64 v[48:49], v137 offset:36608
    v_exp_f32 v24, v24
    v_exp_f32 v25, v25
    v_exp_f32 v26, v26
    s_waitcnt lgkmcnt(3)
    v_exp_f32_e64 v27, v27
    v_smfmac_f32_32x32x32_bf16 v[64:79], v[56:59], v[36:43], v167
    ds_read_b128 v[56:59], v139 offset:30976
    v_exp_f32 v36, v28
    v_exp_f32 v37, v29
    v_exp_f32 v38, v30
    s_waitcnt lgkmcnt(3)
    v_exp_f32_e64 v39, v31
    v_smfmac_f32_32x32x32_bf16 v[64:79], v[52:55], v[20:27], v167
    ds_read_b128 v[52:55], v138 offset:33792
    v_exp_f32 v40, v32
    v_exp_f32 v41, v33
    v_exp_f32 v42, v34
    s_waitcnt lgkmcnt(3)
    v_exp_f32_e64 v43, v35
    v_mfma_f32_32x32x16_bf16 v[20:35], v[44:47], v[60:63], 0
    ds_read_b128 v[44:47], v136 offset:39424
    v_exp_f32 v4, v4
    v_exp_f32 v5, v5
    v_exp_f32 v6, v6
    s_waitcnt lgkmcnt(3)
    v_exp_f32_e64 v7, v7
    v_mfma_f32_32x32x8_bf16 v[20:35], v[48:49], v[50:51], v[20:35]
    ds_read_b64 v[48:49], v137 offset:39424
    v_exp_f32 v8, v8
    v_exp_f32 v9, v9
    v_exp_f32 v10, v10
    s_waitcnt lgkmcnt(3)
    v_exp_f32_e64 v11, v11
    v_smfmac_f32_32x32x32_bf16 v[64:79], v[56:59], v[36:43], v167
    ds_read_b128 v[56:59], v139 offset:33792
    v_exp_f32 v36, v12
    v_exp_f32 v37, v13
    v_exp_f32 v38, v14
    s_waitcnt lgkmcnt(3)
    v_exp_f32_e64 v39, v15
    v_smfmac_f32_32x32x32_bf16 v[64:79], v[52:55], v[4:11], v167
    ds_read_b128 v[52:55], v138 offset:36608
    v_exp_f32 v40, v16
    v_exp_f32 v41, v17
    v_exp_f32 v42, v18
    s_waitcnt lgkmcnt(3)
    v_exp_f32 v43, v19
    s_barrier
    v_mfma_f32_32x32x16_bf16 v[4:19], v[44:47], v[60:63], 0
    ds_read_b128 v[44:47], v136 offset:42240
    v_exp_f32 v20, v20
    v_exp_f32 v21, v21
    v_exp_f32 v22, v22
    s_waitcnt lgkmcnt(3)
    v_exp_f32_e64 v23, v23
    v_mfma_f32_32x32x8_bf16 v[4:19], v[48:49], v[50:51], v[4:19]
    ds_read_b64 v[48:49], v137 offset:42240
    v_exp_f32 v24, v24
    v_exp_f32 v25, v25
    v_exp_f32 v26, v26
    s_waitcnt lgkmcnt(3)
    v_exp_f32_e64 v27, v27
    v_smfmac_f32_32x32x32_bf16 v[64:79], v[56:59], v[36:43], v167
    ds_read_b128 v[56:59], v139 offset:36608
    v_exp_f32 v36, v28
    v_exp_f32 v37, v29
    v_exp_f32 v38, v30
    s_waitcnt lgkmcnt(3)
    v_exp_f32_e64 v39, v31
    v_smfmac_f32_32x32x32_bf16 v[64:79], v[52:55], v[20:27], v167
    ds_read_b128 v[52:55], v138 offset:39424
    v_exp_f32 v40, v32
    v_exp_f32 v41, v33
    v_exp_f32 v42, v34
    s_waitcnt lgkmcnt(3)
    v_exp_f32_e64 v43, v35
    v_mfma_f32_32x32x16_bf16 v[20:35], v[44:47], v[60:63], 0
    v_exp_f32 v4, v4
    v_exp_f32 v5, v5
    v_exp_f32 v6, v6
    s_waitcnt lgkmcnt(2)
    v_exp_f32_e64 v7, v7
    v_mfma_f32_32x32x8_bf16 v[20:35], v[48:49], v[50:51], v[20:35]
    v_exp_f32 v8, v8
    v_exp_f32 v9, v9
    v_exp_f32 v10, v10
    s_waitcnt lgkmcnt(1)
    v_exp_f32_e64 v11, v11
    v_smfmac_f32_32x32x32_bf16 v[64:79], v[56:59], v[36:43], v167
    ds_read_b128 v[56:59], v139 offset:39424
    v_exp_f32 v36, v12
    v_exp_f32 v37, v13
    v_exp_f32 v38, v14
    s_waitcnt lgkmcnt(1)
    v_exp_f32_e64 v39, v15
    v_smfmac_f32_32x32x32_bf16 v[64:79], v[52:55], v[4:11], v167
    ds_read_b128 v[52:55], v138 offset:42240
    v_exp_f32 v40, v16
    v_exp_f32 v41, v17
    v_exp_f32 v42, v18
    v_exp_f32 v43, v19
    v_exp_f32 v20, v20
    v_exp_f32 v21, v21
    v_exp_f32 v22, v22
    v_exp_f32 v23, v23
    v_exp_f32 v24, v24
    v_exp_f32 v25, v25
    v_exp_f32 v26, v26
    s_waitcnt lgkmcnt(1)
    v_exp_f32_e64 v27, v27
    v_smfmac_f32_32x32x32_bf16 v[64:79], v[56:59], v[36:43], v167
    ds_read_b128 v[56:59], v139 offset:42240
    v_exp_f32 v36, v28
    v_exp_f32 v37, v29
    v_exp_f32 v38, v30
    s_waitcnt lgkmcnt(1)
    v_exp_f32_e64 v39, v31
    v_smfmac_f32_32x32x32_bf16 v[64:79], v[52:55], v[20:27], v167
    v_exp_f32 v40, v32
    v_exp_f32 v41, v33
    v_exp_f32 v42, v34
    v_exp_f32 v43, v35
    s_mov_b32 s44, s32
    s_mov_b32 s45, s33
    s_mov_b32 s46, 5242880
    s_mov_b32 s47, 0x20000
    s_waitcnt lgkmcnt(0)
    v_smfmac_f32_32x32x32_bf16 v[64:79], v[56:59], v[36:43], v167
    s_mov_b32 s74, 51200
    s_mov_b32 s75, -51200
    s_nop 9
    v_cmp_nge_f32 vcc, 0x53800000, v76
    s_nop 1
    s_cbranch_vccnz AT_fallback
AT_ok:
    s_cmp_ge_u32 s3, 4
    s_cbranch_scc1 TLz_start
    ds_read_b128 v[20:23], v157 offset:0
    ds_read_b128 v[24:27], v157 offset:3200
    ds_read_b128 v[28:31], v157 offset:6400
    ds_read_b128 v[32:35], v157 offset:9600
    ds_read_b64 v[36:37], v158 offset:0
    ds_read_b64 v[38:39], v158 offset:6400
    ds_read_b128 v[40:43], v157 offset:12800
    ds_read_b128 v[44:47], v157 offset:16000
    ds_read_b128 v[48:51], v157 offset:19200
    ds_read_b128 v[52:55], v157 offset:22400
    ds_read_b64 v[56:57], v158 offset:12800
    ds_read_b64 v[58:59], v158 offset:19200
    v_rcp_f32 v76, v76
    s_add_u32 s8, s81, 0
    s_add_u32 s9, s82, 0
    v_pk_mul_f32 v[64:65], v[64:65], v[76:77] op_sel_hi:[1,0]
    v_pk_mul_f32 v[66:67], v[66:67], v[76:77] op_sel_hi:[1,0]
    v_pk_mul_f32 v[68:69], v[68:69], v[76:77] op_sel_hi:[1,0]
    v_pk_mul_f32 v[70:71], v[70:71], v[76:77] op_sel_hi:[1,0]
    v_pk_mul_f32 v[72:73], v[72:73], v[76:77] op_sel_hi:[1,0]
    v_pk_mul_f32 v[74:75], v[74:75], v[76:77] op_sel_hi:[1,0]
    v_cvt_pk_bf16_f32 v64, v64, v65
    v_cvt_pk_bf16_f32 v65, v66, v67
    v_cvt_pk_bf16_f32 v66, v68, v69
    v_cvt_pk_bf16_f32 v67, v70, v71
    v_cvt_pk_bf16_f32 v68, v72, v73
    v_cvt_pk_bf16_f32 v69, v74, v75
    buffer_store_dwordx4 v[64:67], v146, s[40:43], s8 offen sc1
    s_mov_b32 exec_hi, 0
    buffer_store_dwordx2 v[68:69], v145, s[40:43], s9 offen sc1
    s_mov_b32 exec_hi, -1
.p2align 3
    s_waitcnt lgkmcnt(0)
    s_barrier
    ds_read_b128 v[100:103], v159 offset:0
    ds_read_b128 v[104:107], v159 offset:1024
    ds_read_b128 v[108:111], v159 offset:2048
    ds_read_b128 v[112:115], v159 offset:3072
    ds_read_b64 v[116:117], v160 offset:4096
    ds_read_b64 v[118:119], v160 offset:4608
    ds_read_b128 v[120:123], v159 offset:10240
    ds_read_b128 v[124:127], v159 offset:11264
    ds_read_b128 v[128:131], v159 offset:12288
    ds_read_b128 v[132:135], v159 offset:13312
    ds_read_b64 v[136:137], v160 offset:14336
    ds_read_b64 v[138:139], v160 offset:14848
    s_waitcnt lgkmcnt(11)
    s_nop 0
    v_mfma_f32_32x32x16_bf16 v[4:19], v[20:23], v[100:103], 0
    ds_read_b128 v[60:63], v157 offset:25600
    ds_read_b128 v[64:67], v157 offset:28800
    s_waitcnt lgkmcnt(12)
    s_nop 0
    v_mfma_f32_32x32x16_bf16 v[4:19], v[24:27], v[104:107], v[4:19]
    ds_read_b128 v[68:71], v157 offset:32000
    ds_read_b128 v[72:75], v157 offset:35200
    s_waitcnt lgkmcnt(13)
    s_nop 0
    v_mfma_f32_32x32x16_bf16 v[4:19], v[28:31], v[108:111], v[4:19]
    ds_read_b64 v[76:77], v158 offset:25600
    ds_read_b64 v[78:79], v158 offset:32000
    s_waitcnt lgkmcnt(14)
    s_nop 0
    v_mfma_f32_32x32x16_bf16 v[4:19], v[32:35], v[112:115], v[4:19]
    ds_read_b128 v[80:83], v157 offset:38400
    ds_read_b128 v[84:87], v157 offset:41600
    s_waitcnt lgkmcnt(14)
    s_nop 0
    v_mfma_f32_32x32x16_bf16 v[4:19], v[36:39], v[116:119], v[4:19]
    ds_read_b128 v[88:91], v157 offset:44800
    ds_read_b128 v[92:95], v157 offset:48000
    s_waitcnt lgkmcnt(15)
    s_nop 0
    v_mfma_f32_32x32x16_bf16 v[4:19], v[40:43], v[120:123], v[4:19]
    ds_read_b64 v[96:97], v158 offset:38400
    ds_read_b64 v[98:99], v158 offset:44800
    s_waitcnt lgkmcnt(0)
    s_barrier
    ds_read_b128 v[100:103], v159 offset:20480
    ds_read_b128 v[104:107], v159 offset:21504
    v_mfma_f32_32x32x16_bf16 v[4:19], v[44:47], v[124:127], v[4:19]
    ds_read_b128 v[108:111], v159 offset:22528
    ds_read_b128 v[112:115], v159 offset:23552
    v_mfma_f32_32x32x16_bf16 v[4:19], v[48:51], v[128:131], v[4:19]
    ds_read_b64 v[116:117], v160 offset:24576
    ds_read_b64 v[118:119], v160 offset:25088
    ds_read_b128 v[120:123], v159 offset:30720
    v_mfma_f32_32x32x16_bf16 v[4:19], v[52:55], v[132:135], v[4:19]
    ds_read_b128 v[124:127], v159 offset:31744
    ds_read_b128 v[128:131], v159 offset:32768
    v_mfma_f32_32x32x16_bf16 v[4:19], v[56:59], v[136:139], v[4:19]
    ds_read_b128 v[132:135], v159 offset:33792
    ds_read_b64 v[136:137], v160 offset:34816
    ds_read_b64 v[138:139], v160 offset:35328
    v_add_u32 v157, s74, v157
    v_add_u32 v158, s74, v158
    s_waitcnt lgkmcnt(11)
    s_nop 0
    v_mfma_f32_32x32x16_bf16 v[4:19], v[60:63], v[100:103], v[4:19]
    ds_read_b128 v[20:23], v157 offset:0
    ds_read_b128 v[24:27], v157 offset:3200
    s_waitcnt lgkmcnt(12)
    s_nop 0
    v_mfma_f32_32x32x16_bf16 v[4:19], v[64:67], v[104:107], v[4:19]
    ds_read_b128 v[28:31], v157 offset:6400
    ds_read_b128 v[32:35], v157 offset:9600
    s_waitcnt lgkmcnt(13)
    s_nop 0
    v_mfma_f32_32x32x16_bf16 v[4:19], v[68:71], v[108:111], v[4:19]
    ds_read_b64 v[36:37], v158 offset:0
    ds_read_b64 v[38:39], v158 offset:6400
    s_waitcnt lgkmcnt(14)
    s_nop 0
    v_mfma_f32_32x32x16_bf16 v[4:19], v[72:75], v[112:115], v[4:19]
    ds_read_b128 v[40:43], v157 offset:12800
    ds_read_b128 v[44:47], v157 offset:16000
    s_waitcnt lgkmcnt(14)
    s_nop 0
    v_mfma_f32_32x32x16_bf16 v[4:19], v[76:79], v[116:119], v[4:19]
    ds_read_b128 v[48:51], v157 offset:19200
    ds_read_b128 v[52:55], v157 offset:22400
    s_waitcnt lgkmcnt(15)
    s_nop 0
    v_mfma_f32_32x32x16_bf16 v[4:19], v[80:83], v[120:123], v[4:19]
    ds_read_b64 v[56:57], v158 offset:12800
    ds_read_b64 v[58:59], v158 offset:19200
    v_lshrrev_b32 v161, 2, v0
    v_and_b32 v3, 3, v0
    s_mul_i32 s8, s3, 2560
    s_add_u32 s8, s8, 143360
    v_mul_u32_u24 v162, 80, v1
    v_lshl_add_u32 v162, v2, 3, v162
    v_add_u32 v162, s8, v162
    v_lshlrev_b32 v3, 4, v3
    v_mul_u32_u24 v163, 80, v161
    v_add3_u32 v163, v163, v3, s8
    v_mul_u32_u24 v161, 2560, v161
    v_add_u32 v161, v161, v3
    s_add_u32 s81, s80, 40960
.p2align 3
    s_waitcnt lgkmcnt(0)
    s_barrier
    ds_read_b128 v[100:103], v159 offset:40960
    ds_read_b128 v[104:107], v159 offset:41984
    v_mfma_f32_32x32x16_bf16 v[4:19], v[84:87], v[124:127], v[4:19]
    ds_read_b128 v[108:111], v159 offset:43008
    ds_read_b128 v[112:115], v159 offset:44032
    v_mfma_f32_32x32x16_bf16 v[4:19], v[88:91], v[128:131], v[4:19]
    ds_read_b64 v[116:117], v160 offset:45056
    ds_read_b64 v[118:119], v160 offset:45568
    ds_read_b128 v[120:123], v159 offset:51200
    v_mfma_f32_32x32x16_bf16 v[4:19], v[92:95], v[132:135], v[4:19]
    ds_read_b128 v[124:127], v159 offset:52224
    ds_read_b128 v[128:131], v159 offset:53248
    v_mfma_f32_32x32x16_bf16 v[4:19], v[96:99], v[136:139], v[4:19]
    ds_read_b128 v[132:135], v159 offset:54272
    ds_read_b64 v[136:137], v160 offset:55296
    ds_read_b64 v[138:139], v160 offset:55808
    s_waitcnt lgkmcnt(11)
    s_nop 0
    v_mfma_f32_32x32x16_bf16 v[4:19], v[20:23], v[100:103], v[4:19]
    ds_read_b128 v[60:63], v157 offset:25600
    ds_read_b128 v[64:67], v157 offset:28800
    s_waitcnt lgkmcnt(12)
    s_nop 0
    v_mfma_f32_32x32x16_bf16 v[4:19], v[24:27], v[104:107], v[4:19]
    ds_read_b128 v[68:71], v157 offset:32000
    ds_read_b128 v[72:75], v157 offset:35200
    s_waitcnt lgkmcnt(13)
    s_nop 0
    v_mfma_f32_32x32x16_bf16 v[4:19], v[28:31], v[108:111], v[4:19]
    ds_read_b64 v[76:77], v158 offset:25600
    ds_read_b64 v[78:79], v158 offset:32000
    s_waitcnt lgkmcnt(14)
    s_nop 0
    v_mfma_f32_32x32x16_bf16 v[4:19], v[32:35], v[112:115], v[4:19]
    ds_read_b128 v[80:83], v157 offset:38400
    ds_read_b128 v[84:87], v157 offset:41600
    s_waitcnt lgkmcnt(14)
    s_nop 0
    v_mfma_f32_32x32x16_bf16 v[4:19], v[36:39], v[116:119], v[4:19]
    ds_read_b128 v[88:91], v157 offset:44800
    ds_read_b128 v[92:95], v157 offset:48000
    s_waitcnt lgkmcnt(15)
    s_nop 0
    v_mfma_f32_32x32x16_bf16 v[4:19], v[40:43], v[120:123], v[4:19]
    ds_read_b64 v[96:97], v158 offset:38400
    ds_read_b64 v[98:99], v158 offset:44800
    s_waitcnt lgkmcnt(0)
    s_barrier
    ds_read_b128 v[100:103], v159 offset:0
    ds_read_b128 v[104:107], v159 offset:1024
    v_mfma_f32_32x32x16_bf16 v[4:19], v[44:47], v[124:127], v[4:19]
    ds_read_b128 v[108:111], v159 offset:2048
    ds_read_b128 v[112:115], v159 offset:3072
    v_mfma_f32_32x32x16_bf16 v[4:19], v[48:51], v[128:131], v[4:19]
    ds_read_b64 v[116:117], v160 offset:4096
    ds_read_b64 v[118:119], v160 offset:4608
    ds_read_b128 v[120:123], v159 offset:10240
    v_mfma_f32_32x32x16_bf16 v[4:19], v[52:55], v[132:135], v[4:19]
    ds_read_b128 v[124:127], v159 offset:11264
    ds_read_b128 v[128:131], v159 offset:12288
    v_mfma_f32_32x32x16_bf16 v[4:19], v[56:59], v[136:139], v[4:19]
    ds_read_b128 v[132:135], v159 offset:13312
    ds_read_b64 v[136:137], v160 offset:14336
    ds_read_b64 v[138:139], v160 offset:14848
    v_add_u32 v157, s75, v157
    v_add_u32 v158, s75, v158
    s_waitcnt lgkmcnt(11)
    s_nop 0
    v_mfma_f32_32x32x16_bf16 v[4:19], v[60:63], v[100:103], v[4:19]
    ds_read_b128 v[20:23], v157 offset:0
    ds_read_b128 v[24:27], v157 offset:3200
    s_waitcnt lgkmcnt(12)
    s_nop 0
    v_mfma_f32_32x32x16_bf16 v[4:19], v[64:67], v[104:107], v[4:19]
    ds_read_b128 v[28:31], v157 offset:6400
    ds_read_b128 v[32:35], v157 offset:9600
    s_waitcnt lgkmcnt(13)
    s_nop 0
    v_mfma_f32_32x32x16_bf16 v[4:19], v[68:71], v[108:111], v[4:19]
    ds_read_b64 v[36:37], v158 offset:0
    ds_read_b64 v[38:39], v158 offset:6400
    s_waitcnt lgkmcnt(14)
    s_nop 0
    v_mfma_f32_32x32x16_bf16 v[4:19], v[72:75], v[112:115], v[4:19]
    ds_read_b128 v[40:43], v157 offset:12800
    ds_read_b128 v[44:47], v157 offset:16000
    s_waitcnt lgkmcnt(14)
    s_nop 0
    v_mfma_f32_32x32x16_bf16 v[4:19], v[76:79], v[116:119], v[4:19]
    ds_read_b128 v[48:51], v157 offset:19200
    ds_read_b128 v[52:55], v157 offset:22400
    s_waitcnt lgkmcnt(15)
    s_nop 0
    v_mfma_f32_32x32x16_bf16 v[4:19], v[80:83], v[120:123], v[4:19]
    ds_read_b64 v[56:57], v158 offset:12800
    ds_read_b64 v[58:59], v158 offset:19200
    s_waitcnt vmcnt(0) lgkmcnt(0)
    s_barrier
    ds_read_b128 v[100:103], v159 offset:20480
    ds_read_b128 v[104:107], v159 offset:21504
    v_mfma_f32_32x32x16_bf16 v[4:19], v[84:87], v[124:127], v[4:19]
    ds_read_b128 v[108:111], v159 offset:22528
    ds_read_b128 v[112:115], v159 offset:23552
    v_mfma_f32_32x32x16_bf16 v[4:19], v[88:91], v[128:131], v[4:19]
    ds_read_b64 v[116:117], v160 offset:24576
    ds_read_b64 v[118:119], v160 offset:25088
    ds_read_b128 v[120:123], v159 offset:30720
    v_mfma_f32_32x32x16_bf16 v[4:19], v[92:95], v[132:135], v[4:19]
    ds_read_b128 v[124:127], v159 offset:31744
    ds_read_b128 v[128:131], v159 offset:32768
    v_mfma_f32_32x32x16_bf16 v[4:19], v[96:99], v[136:139], v[4:19]
    ds_read_b128 v[132:135], v159 offset:33792
    ds_read_b64 v[136:137], v160 offset:34816
    ds_read_b64 v[138:139], v160 offset:35328
    s_waitcnt lgkmcnt(11)
    s_nop 0
    v_mfma_f32_32x32x16_bf16 v[140:155], v[20:23], v[100:103], 0
    ds_read_b128 v[60:63], v157 offset:25600
    ds_read_b128 v[64:67], v157 offset:28800
    s_waitcnt lgkmcnt(12)
    s_nop 0
    v_mfma_f32_32x32x16_bf16 v[140:155], v[24:27], v[104:107], v[140:155]
    ds_read_b128 v[68:71], v157 offset:32000
    ds_read_b128 v[72:75], v157 offset:35200
    s_waitcnt lgkmcnt(13)
    s_nop 0
    v_mfma_f32_32x32x16_bf16 v[140:155], v[28:31], v[108:111], v[140:155]
    ds_read_b64 v[76:77], v158 offset:25600
    ds_read_b64 v[78:79], v158 offset:32000
    s_waitcnt lgkmcnt(14)
    s_nop 0
    v_mfma_f32_32x32x16_bf16 v[140:155], v[32:35], v[112:115], v[140:155]
    ds_read_b128 v[80:83], v157 offset:38400
    ds_read_b128 v[84:87], v157 offset:41600
    s_waitcnt lgkmcnt(14)
    s_nop 0
    v_mfma_f32_32x32x16_bf16 v[140:155], v[36:39], v[116:119], v[140:155]
    ds_read_b128 v[88:91], v157 offset:44800
    ds_read_b128 v[92:95], v157 offset:48000
    s_waitcnt lgkmcnt(15)
    s_nop 0
    v_mfma_f32_32x32x16_bf16 v[140:155], v[40:43], v[120:123], v[140:155]
    ds_read_b64 v[96:97], v158 offset:38400
    ds_read_b64 v[98:99], v158 offset:44800
    v_cmp_u_f32 s[48:49], v4, v4
    v_cvt_pk_bf16_f32 v4, v4, v5
    v_cvt_pk_bf16_f32 v5, v6, v7
    v_cvt_pk_bf16_f32 v6, v8, v9
    v_cvt_pk_bf16_f32 v7, v10, v11
    v_cvt_pk_bf16_f32 v8, v12, v13
    v_cvt_pk_bf16_f32 v9, v14, v15
    v_cvt_pk_bf16_f32 v10, v16, v17
    v_cvt_pk_bf16_f32 v11, v18, v19
    s_waitcnt lgkmcnt(12)
    s_barrier
    ds_read_b128 v[100:103], v159 offset:40960
    ds_read_b128 v[104:107], v159 offset:41984
    v_mfma_f32_32x32x16_bf16 v[140:155], v[44:47], v[124:127], v[140:155]
    ds_read_b128 v[108:111], v159 offset:43008
    ds_read_b128 v[112:115], v159 offset:44032
    v_mfma_f32_32x32x16_bf16 v[140:155], v[48:51], v[128:131], v[140:155]
    ds_read_b64 v[116:117], v160 offset:45056
    ds_read_b64 v[118:119], v160 offset:45568
    ds_read_b128 v[120:123], v159 offset:51200
    v_mfma_f32_32x32x16_bf16 v[140:155], v[52:55], v[132:135], v[140:155]
    ds_read_b128 v[124:127], v159 offset:52224
    ds_read_b128 v[128:131], v159 offset:53248
    v_mfma_f32_32x32x16_bf16 v[140:155], v[56:59], v[136:139], v[140:155]
    ds_read_b128 v[132:135], v159 offset:54272
    ds_read_b64 v[136:137], v160 offset:55296
    ds_read_b64 v[138:139], v160 offset:55808
    v_add_u32 v157, s74, v157
    v_add_u32 v158, s74, v158
    s_waitcnt lgkmcnt(11)
    s_nop 0
    v_mfma_f32_32x32x16_bf16 v[140:155], v[60:63], v[100:103], v[140:155]
    ds_read_b128 v[20:23], v157 offset:0
    ds_read_b128 v[24:27], v157 offset:3200
    s_waitcnt lgkmcnt(12)
    s_nop 0
    v_mfma_f32_32x32x16_bf16 v[140:155], v[64:67], v[104:107], v[140:155]
    ds_read_b128 v[28:31], v157 offset:6400
    ds_read_b128 v[32:35], v157 offset:9600
    s_waitcnt lgkmcnt(13)
    s_nop 0
    v_mfma_f32_32x32x16_bf16 v[140:155], v[68:71], v[108:111], v[140:155]
    ds_read_b64 v[36:37], v158 offset:0
    ds_read_b64 v[38:39], v158 offset:6400
    s_waitcnt lgkmcnt(14)
    s_nop 0
    v_mfma_f32_32x32x16_bf16 v[140:155], v[72:75], v[112:115], v[140:155]
    ds_read_b128 v[40:43], v157 offset:12800
    ds_read_b128 v[44:47], v157 offset:16000
    s_waitcnt lgkmcnt(14)
    s_nop 0
    v_mfma_f32_32x32x16_bf16 v[140:155], v[76:79], v[116:119], v[140:155]
    ds_read_b128 v[48:51], v157 offset:19200
    ds_read_b128 v[52:55], v157 offset:22400
    s_waitcnt lgkmcnt(15)
    s_nop 0
    v_mfma_f32_32x32x16_bf16 v[140:155], v[80:83], v[120:123], v[140:155]
    ds_read_b64 v[56:57], v158 offset:12800
    ds_read_b64 v[58:59], v158 offset:19200
    s_waitcnt lgkmcnt(12)
    s_barrier
    ds_read_b128 v[100:103], v159 offset:0
    ds_read_b128 v[104:107], v159 offset:1024
    v_mfma_f32_32x32x16_bf16 v[140:155], v[84:87], v[124:127], v[140:155]
    ds_read_b128 v[108:111], v159 offset:2048
    ds_read_b128 v[112:115], v159 offset:3072
    v_mfma_f32_32x32x16_bf16 v[140:155], v[88:91], v[128:131], v[140:155]
    ds_read_b64 v[116:117], v160 offset:4096
    ds_read_b64 v[118:119], v160 offset:4608
    ds_read_b128 v[120:123], v159 offset:10240
    v_mfma_f32_32x32x16_bf16 v[140:155], v[92:95], v[132:135], v[140:155]
    ds_read_b128 v[124:127], v159 offset:11264
    ds_read_b128 v[128:131], v159 offset:12288
    v_mfma_f32_32x32x16_bf16 v[140:155], v[96:99], v[136:139], v[140:155]
    ds_read_b128 v[132:135], v159 offset:13312
    ds_read_b64 v[136:137], v160 offset:14336
    ds_read_b64 v[138:139], v160 offset:14848
    s_waitcnt lgkmcnt(11)
    s_nop 0
    v_mfma_f32_32x32x16_bf16 v[140:155], v[20:23], v[100:103], v[140:155]
    ds_read_b128 v[60:63], v157 offset:25600
    ds_read_b128 v[64:67], v157 offset:28800
    s_waitcnt lgkmcnt(12)
    s_nop 0
    v_mfma_f32_32x32x16_bf16 v[140:155], v[24:27], v[104:107], v[140:155]
    ds_read_b128 v[68:71], v157 offset:32000
    ds_read_b128 v[72:75], v157 offset:35200
    s_waitcnt lgkmcnt(13)
    s_nop 0
    v_mfma_f32_32x32x16_bf16 v[140:155], v[28:31], v[108:111], v[140:155]
    ds_read_b64 v[76:77], v158 offset:25600
    ds_read_b64 v[78:79], v158 offset:32000
    s_waitcnt lgkmcnt(14)
    s_nop 0
    v_mfma_f32_32x32x16_bf16 v[140:155], v[32:35], v[112:115], v[140:155]
    ds_read_b128 v[80:83], v157 offset:38400
    ds_read_b128 v[84:87], v157 offset:41600
    s_waitcnt lgkmcnt(14)
    s_nop 0
    v_mfma_f32_32x32x16_bf16 v[140:155], v[36:39], v[116:119], v[140:155]
    ds_read_b128 v[88:91], v157 offset:44800
    ds_read_b128 v[92:95], v157 offset:48000
    s_waitcnt lgkmcnt(15)
    s_nop 0
    v_mfma_f32_32x32x16_bf16 v[140:155], v[40:43], v[120:123], v[140:155]
    ds_read_b64 v[96:97], v158 offset:38400
    ds_read_b64 v[98:99], v158 offset:44800
    s_waitcnt lgkmcnt(12)
    s_barrier
    s_mov_b32 s8, -102400
    v_add_u32 v159, s8, v159
    v_add_u32 v160, s8, v160
    ds_read_b128 v[100:103], v159 offset:0
    ds_read_b128 v[104:107], v159 offset:1024
    v_mfma_f32_32x32x16_bf16 v[140:155], v[44:47], v[124:127], v[140:155]
    ds_read_b128 v[108:111], v159 offset:2048
    ds_read_b128 v[112:115], v159 offset:3072
    v_mfma_f32_32x32x16_bf16 v[140:155], v[48:51], v[128:131], v[140:155]
    ds_read_b64 v[116:117], v160 offset:4096
    ds_read_b64 v[118:119], v160 offset:4608
    ds_read_b128 v[120:123], v159 offset:10240
    v_mfma_f32_32x32x16_bf16 v[140:155], v[52:55], v[132:135], v[140:155]
    ds_read_b128 v[124:127], v159 offset:11264
    ds_read_b128 v[128:131], v159 offset:12288
    v_mfma_f32_32x32x16_bf16 v[140:155], v[56:59], v[136:139], v[140:155]
    ds_read_b128 v[132:135], v159 offset:13312
    ds_read_b64 v[136:137], v160 offset:14336
    ds_read_b64 v[138:139], v160 offset:14848
    s_waitcnt lgkmcnt(11)
    s_nop 0
    v_mfma_f32_32x32x16_bf16 v[140:155], v[60:63], v[100:103], v[140:155]
    ds_write_b64 v162, v[4:5] offset:0
    ds_write_b64 v162, v[6:7] offset:16
    ds_write_b64 v162, v[8:9] offset:32
    ds_write_b64 v162, v[10:11] offset:48
    ds_read_b128 v[4:7], v163 offset:0
    ds_read_b128 v[8:11], v163 offset:1280
    s_waitcnt lgkmcnt(15)
    s_nop 0
    v_mfma_f32_32x32x16_bf16 v[140:155], v[64:67], v[104:107], v[140:155]
    s_waitcnt lgkmcnt(15)
    s_nop 0
    v_mfma_f32_32x32x16_bf16 v[140:155], v[68:71], v[108:111], v[140:155]
    s_waitcnt lgkmcnt(14)
    s_nop 0
    v_mfma_f32_32x32x16_bf16 v[140:155], v[72:75], v[112:115], v[140:155]
    s_waitcnt lgkmcnt(12)
    s_nop 0
    v_mfma_f32_32x32x16_bf16 v[140:155], v[76:79], v[116:119], v[140:155]
    s_waitcnt lgkmcnt(11)
    s_nop 0
    v_mfma_f32_32x32x16_bf16 v[140:155], v[80:83], v[120:123], v[140:155]
    s_waitcnt lgkmcnt(10)
    s_nop 0
    v_mfma_f32_32x32x16_bf16 v[140:155], v[84:87], v[124:127], v[140:155]
    s_waitcnt lgkmcnt(0)
    s_nop 0
    buffer_store_dwordx4 v[4:7], v161, s[44:47], s80 offen offset:1280 nt
    buffer_store_dwordx4 v[8:11], v161, s[44:47], s81 offen offset:1280 nt
    s_waitcnt lgkmcnt(9)
    s_nop 0
    v_mfma_f32_32x32x16_bf16 v[140:155], v[88:91], v[128:131], v[140:155]
    s_waitcnt lgkmcnt(8)
    s_nop 0
    v_mfma_f32_32x32x16_bf16 v[140:155], v[92:95], v[132:135], v[140:155]
    s_waitcnt lgkmcnt(6)
    s_nop 0
    v_mfma_f32_32x32x16_bf16 v[140:155], v[96:99], v[136:139], v[140:155]
    s_nop 11
    v_cmp_u_f32 s[50:51], v140, v140
    v_cvt_pk_bf16_f32 v140, v140, v141
    v_cvt_pk_bf16_f32 v141, v142, v143
    v_cvt_pk_bf16_f32 v142, v144, v145
    v_cvt_pk_bf16_f32 v143, v146, v147
    v_cvt_pk_bf16_f32 v144, v148, v149
    v_cvt_pk_bf16_f32 v145, v150, v151
    v_cvt_pk_bf16_f32 v146, v152, v153
    v_cvt_pk_bf16_f32 v147, v154, v155
    ds_write_b64 v162, v[140:141] offset:0
    ds_write_b64 v162, v[142:143] offset:16
    ds_write_b64 v162, v[144:145] offset:32
    ds_write_b64 v162, v[146:147] offset:48
    ds_read_b128 v[140:143], v163 offset:0
    ds_read_b128 v[144:147], v163 offset:1280
    s_waitcnt lgkmcnt(0)
    buffer_store_dwordx4 v[140:143], v161, s[44:47], s80 offen offset:0 nt
    buffer_store_dwordx4 v[144:147], v161, s[44:47], s81 offen offset:0 nt
    s_or_b64 vcc, s[48:49], s[50:51]
    s_cbranch_scc1 TLm_redo
TLm_end:
    s_endpgm
TLm_redo:
    v_add_u32 v157, s75, v157
    v_add_u32 v158, s75, v158
    v_lshlrev_b32 v100, 2, v0
    s_lshl_b32 s52, s4, 7
    s_add_u32 s52, s52, 7569408
    s_mul_i32 s13, s4, 81920
    s_mul_i32 s53, s5, 102400
    s_add_u32 s53, s53, 8421376
    s_mov_b32 s54, 0
TLm_rj:
    s_mov_b32 exec_lo, 0xff
    s_mov_b32 exec_hi, 0x0
    s_mov_b32 s9, 0
Lpoll_5:
    buffer_load_dword v101, v100, s[40:43], s52 offen sc1
    s_add_u32 s9, s9, 1
    s_waitcnt vmcnt(0)
    v_cmp_ne_u32 vcc, s96, v101
    s_cmp_gt_u32 s9, 131072
    s_cbranch_scc1 Lpd_6
    s_cbranch_vccz Lpd_6
    s_sleep 1
    s_branch Lpoll_5
Lpd_6:
    s_mov_b64 exec, -1
    v_mov_b32 v4, 0
    v_mov_b32 v5, 0
    v_mov_b32 v6, 0
    v_mov_b32 v7, 0
    v_mov_b32 v8, 0
    v_mov_b32 v9, 0
    v_mov_b32 v10, 0
    v_mov_b32 v11, 0
    v_mov_b32 v12, 0
    v_mov_b32 v13, 0
    v_mov_b32 v14, 0
    v_mov_b32 v15, 0
    v_mov_b32 v16, 0
    v_mov_b32 v17, 0
    v_mov_b32 v18, 0
    v_mov_b32 v19, 0
    s_add_u32 s69, s5, s4
    s_mov_b32 s56, 0
TLm_rl:
    s_and_b32 s69, s69, 3
    s_mul_i32 s8, s69, 20480
    s_add_u32 s8, s8, s13
    s_add_u32 s9, s8, 4096
    s_add_u32 s10, s8, 10240
    s_add_u32 s11, s8, 14336
    s_mul_i32 s12, s69, 25600
    s_add_u32 s12, s12, s53
    buffer_load_dwordx4 v[24:27], v159, s[40:43], s8 offen offset:0 sc1
    s_add_u32 s14, s12, 0
    buffer_load_dwordx4 v[20:23], v157, s[40:43], s14 offen sc1
    buffer_load_dwordx4 v[32:35], v159, s[40:43], s8 offen offset:1024 sc1
    s_add_u32 s14, s12, 3200
    buffer_load_dwordx4 v[28:31], v157, s[40:43], s14 offen sc1
    buffer_load_dwordx4 v[40:43], v159, s[40:43], s8 offen offset:2048 sc1
    s_add_u32 s14, s12, 6400
    buffer_load_dwordx4 v[36:39], v157, s[40:43], s14 offen sc1
    buffer_load_dwordx4 v[48:51], v159, s[40:43], s8 offen offset:3072 sc1
    s_add_u32 s14, s12, 9600
    buffer_load_dwordx4 v[44:47], v157, s[40:43], s14 offen sc1
    buffer_load_dwordx2 v[56:57], v160, s[40:43], s9 offen offset:0 sc1
    s_add_u32 s14, s12, 0
    buffer_load_dwordx2 v[52:53], v158, s[40:43], s14 offen sc1
    buffer_load_dwordx2 v[58:59], v160, s[40:43], s9 offen offset:512 sc1
    s_add_u32 s14, s12, 6400
    buffer_load_dwordx2 v[54:55], v158, s[40:43], s14 offen sc1
    buffer_load_dwordx4 v[64:67], v159, s[40:43], s10 offen offset:0 sc1
    s_add_u32 s14, s12, 12800
    buffer_load_dwordx4 v[60:63], v157, s[40:43], s14 offen sc1
    buffer_load_dwordx4 v[72:75], v159, s[40:43], s10 offen offset:1024 sc1
    s_add_u32 s14, s12, 16000
    buffer_load_dwordx4 v[68:71], v157, s[40:43], s14 offen sc1
    buffer_load_dwordx4 v[80:83], v159, s[40:43], s10 offen offset:2048 sc1
    s_add_u32 s14, s12, 19200
    buffer_load_dwordx4 v[76:79], v157, s[40:43], s14 offen sc1
    buffer_load_dwordx4 v[88:91], v159, s[40:43], s10 offen offset:3072 sc1
    s_add_u32 s14, s12, 22400
    buffer_load_dwordx4 v[84:87], v157, s[40:43], s14 offen sc1
    buffer_load_dwordx2 v[96:97], v160, s[40:43], s11 offen offset:0 sc1
    s_add_u32 s14, s12, 12800
    buffer_load_dwordx2 v[92:93], v158, s[40:43], s14 offen sc1
    buffer_load_dwordx2 v[98:99], v160, s[40:43], s11 offen offset:512 sc1
    s_add_u32 s14, s12, 19200
    buffer_load_dwordx2 v[94:95], v158, s[40:43], s14 offen sc1
    s_waitcnt vmcnt(0)
    v_mfma_f32_32x32x16_bf16 v[4:19], v[20:23], v[24:27], v[4:19]
    v_mfma_f32_32x32x16_bf16 v[4:19], v[28:31], v[32:35], v[4:19]
    v_mfma_f32_32x32x16_bf16 v[4:19], v[36:39], v[40:43], v[4:19]
    v_mfma_f32_32x32x16_bf16 v[4:19], v[44:47], v[48:51], v[4:19]
    v_mfma_f32_32x32x16_bf16 v[4:19], v[52:55], v[56:59], v[4:19]
    v_mfma_f32_32x32x16_bf16 v[4:19], v[60:63], v[64:67], v[4:19]
    v_mfma_f32_32x32x16_bf16 v[4:19], v[68:71], v[72:75], v[4:19]
    v_mfma_f32_32x32x16_bf16 v[4:19], v[76:79], v[80:83], v[4:19]
    v_mfma_f32_32x32x16_bf16 v[4:19], v[84:87], v[88:91], v[4:19]
    v_mfma_f32_32x32x16_bf16 v[4:19], v[92:95], v[96:99], v[4:19]
    s_add_u32 s69, s69, 1
    s_add_u32 s56, s56, 1
    s_cmp_lt_u32 s56, 4
    s_cbranch_scc1 TLm_rl
    s_nop 11
    v_cvt_pk_bf16_f32 v132, v4, v5
    v_cvt_pk_bf16_f32 v133, v6, v7
    v_cvt_pk_bf16_f32 v134, v8, v9
    v_cvt_pk_bf16_f32 v135, v10, v11
    v_cvt_pk_bf16_f32 v136, v12, v13
    v_cvt_pk_bf16_f32 v137, v14, v15
    v_cvt_pk_bf16_f32 v138, v16, v17
    v_cvt_pk_bf16_f32 v139, v18, v19
    ds_write_b64 v162, v[132:133] offset:0
    ds_write_b64 v162, v[134:135] offset:16
    ds_write_b64 v162, v[136:137] offset:32
    ds_write_b64 v162, v[138:139] offset:48
    ds_read_b128 v[132:135], v163 offset:0
    ds_read_b128 v[136:139], v163 offset:1280
    s_waitcnt lgkmcnt(0)
    buffer_store_dwordx4 v[132:135], v161, s[44:47], s80 offen offset:0 nt
    buffer_store_dwordx4 v[136:139], v161, s[44:47], s81 offen offset:0 nt
    s_add_u32 s80, s80, 1280
    s_add_u32 s81, s81, 1280
    s_add_u32 s13, s13, 2621440
    s_sub_u32 s52, s52, 32768
    s_sub_u32 s53, s53, 819200
    s_add_u32 s54, s54, 1
    s_cmp_lt_u32 s54, 2
    s_cbranch_scc1 TLm_rj
    s_branch TLm_end
TLz_start:
    ds_read_b128 v[20:23], v157 offset:0
    ds_read_b128 v[28:31], v157 offset:6400
    ds_read_b128 v[36:39], v157 offset:12800
    ds_read_b128 v[44:47], v157 offset:19200
    ds_read_b64 v[52:53], v158 offset:0
    ds_read_b64 v[54:55], v158 offset:12800
    v_rcp_f32 v76, v76
    s_add_u32 s8, s81, 0
    s_add_u32 s9, s82, 0
    v_pk_mul_f32 v[64:65], v[64:65], v[76:77] op_sel_hi:[1,0]
    v_pk_mul_f32 v[66:67], v[66:67], v[76:77] op_sel_hi:[1,0]
    v_pk_mul_f32 v[68:69], v[68:69], v[76:77] op_sel_hi:[1,0]
    v_pk_mul_f32 v[70:71], v[70:71], v[76:77] op_sel_hi:[1,0]
    v_pk_mul_f32 v[72:73], v[72:73], v[76:77] op_sel_hi:[1,0]
    v_pk_mul_f32 v[74:75], v[74:75], v[76:77] op_sel_hi:[1,0]
    v_cvt_pk_bf16_f32 v64, v64, v65
    v_cvt_pk_bf16_f32 v65, v66, v67
    v_cvt_pk_bf16_f32 v66, v68, v69
    v_cvt_pk_bf16_f32 v67, v70, v71
    v_cvt_pk_bf16_f32 v68, v72, v73
    v_cvt_pk_bf16_f32 v69, v74, v75
    buffer_store_dwordx4 v[64:67], v146, s[40:43], s8 offen sc1
    s_mov_b32 exec_hi, 0
    buffer_store_dwordx2 v[68:69], v145, s[40:43], s9 offen sc1
    s_mov_b32 exec_hi, -1
    s_waitcnt lgkmcnt(0)
    s_barrier
    ds_read_b128 v[24:27], v159 offset:0
    ds_read_b128 v[32:35], v159 offset:2048
    ds_read_b128 v[40:43], v159 offset:10240
    ds_read_b128 v[48:51], v159 offset:12288
    ds_read_b64 v[56:57], v160 offset:4096
    ds_read_b64 v[58:59], v160 offset:14336
    s_waitcnt lgkmcnt(5)
    v_mfma_f32_16x16x32_bf16 v[4:7], v[20:23], v[24:27], 0
    ds_read_b128 v[20:23], v157 offset:25600
    s_waitcnt lgkmcnt(5)
    v_mfma_f32_16x16x32_bf16 v[4:7], v[28:31], v[32:35], v[4:7]
    ds_read_b128 v[28:31], v157 offset:32000
    s_waitcnt lgkmcnt(5)
    v_mfma_f32_16x16x32_bf16 v[4:7], v[36:39], v[40:43], v[4:7]
    ds_read_b128 v[36:39], v157 offset:38400
    s_waitcnt lgkmcnt(5)
    v_mfma_f32_16x16x32_bf16 v[4:7], v[44:47], v[48:51], v[4:7]
    ds_read_b128 v[44:47], v157 offset:44800
    s_waitcnt lgkmcnt(4)
    v_mfma_f32_16x16x32_bf16 v[4:7], v[52:55], v[56:59], v[4:7]
    ds_read_b64 v[52:53], v158 offset:25600
    ds_read_b64 v[54:55], v158 offset:38400
    s_waitcnt lgkmcnt(0)
    s_barrier
    ds_read_b128 v[24:27], v159 offset:20480
    ds_read_b128 v[32:35], v159 offset:22528
    ds_read_b128 v[40:43], v159 offset:30720
    ds_read_b128 v[48:51], v159 offset:32768
    ds_read_b64 v[56:57], v160 offset:24576
    ds_read_b64 v[58:59], v160 offset:34816
    v_add_u32 v157, s74, v157
    v_add_u32 v158, s74, v158
    v_lshrrev_b32 v161, 2, v0
    v_and_b32 v3, 3, v0
    v_lshl_add_u32 v163, v3, 4, v161
    v_lshlrev_b32 v163, 2, v163
    v_mul_u32_u24 v161, 2560, v161
    v_lshl_add_u32 v161, v3, 3, v161
    s_waitcnt lgkmcnt(5)
    v_mfma_f32_16x16x32_bf16 v[4:7], v[20:23], v[24:27], v[4:7]
    ds_read_b128 v[20:23], v157 offset:0
    s_waitcnt lgkmcnt(5)
    v_mfma_f32_16x16x32_bf16 v[4:7], v[28:31], v[32:35], v[4:7]
    ds_read_b128 v[28:31], v157 offset:6400
    s_waitcnt lgkmcnt(5)
    v_mfma_f32_16x16x32_bf16 v[4:7], v[36:39], v[40:43], v[4:7]
    ds_read_b128 v[36:39], v157 offset:12800
    s_waitcnt lgkmcnt(5)
    v_mfma_f32_16x16x32_bf16 v[4:7], v[44:47], v[48:51], v[4:7]
    ds_read_b128 v[44:47], v157 offset:19200
    s_waitcnt lgkmcnt(4)
    v_mfma_f32_16x16x32_bf16 v[4:7], v[52:55], v[56:59], v[4:7]
    ds_read_b64 v[52:53], v158 offset:0
    ds_read_b64 v[54:55], v158 offset:12800
    s_waitcnt lgkmcnt(0)
    s_barrier
    ds_read_b128 v[24:27], v159 offset:40960
    ds_read_b128 v[32:35], v159 offset:43008
    ds_read_b128 v[40:43], v159 offset:51200
    ds_read_b128 v[48:51], v159 offset:53248
    ds_read_b64 v[56:57], v160 offset:45056
    ds_read_b64 v[58:59], v160 offset:55296
    s_waitcnt lgkmcnt(5)
    v_mfma_f32_16x16x32_bf16 v[4:7], v[20:23], v[24:27], v[4:7]
    ds_read_b128 v[20:23], v157 offset:25600
    s_waitcnt lgkmcnt(5)
    v_mfma_f32_16x16x32_bf16 v[4:7], v[28:31], v[32:35], v[4:7]
    ds_read_b128 v[28:31], v157 offset:32000
    s_waitcnt lgkmcnt(5)
    v_mfma_f32_16x16x32_bf16 v[4:7], v[36:39], v[40:43], v[4:7]
    ds_read_b128 v[36:39], v157 offset:38400
    s_waitcnt lgkmcnt(5)
    v_mfma_f32_16x16x32_bf16 v[4:7], v[44:47], v[48:51], v[4:7]
    ds_read_b128 v[44:47], v157 offset:44800
    s_waitcnt lgkmcnt(4)
    v_mfma_f32_16x16x32_bf16 v[4:7], v[52:55], v[56:59], v[4:7]
    ds_read_b64 v[52:53], v158 offset:25600
    ds_read_b64 v[54:55], v158 offset:38400
    s_waitcnt lgkmcnt(0)
    s_barrier
    ds_read_b128 v[24:27], v159 offset:0
    ds_read_b128 v[32:35], v159 offset:2048
    ds_read_b128 v[40:43], v159 offset:10240
    ds_read_b128 v[48:51], v159 offset:12288
    ds_read_b64 v[56:57], v160 offset:4096
    ds_read_b64 v[58:59], v160 offset:14336
    v_add_u32 v157, s75, v157
    v_add_u32 v158, s75, v158
    s_waitcnt lgkmcnt(5)
    v_mfma_f32_16x16x32_bf16 v[4:7], v[20:23], v[24:27], v[4:7]
    ds_read_b128 v[20:23], v157 offset:0
    s_waitcnt lgkmcnt(5)
    v_mfma_f32_16x16x32_bf16 v[4:7], v[28:31], v[32:35], v[4:7]
    ds_read_b128 v[28:31], v157 offset:6400
    s_waitcnt lgkmcnt(5)
    v_mfma_f32_16x16x32_bf16 v[4:7], v[36:39], v[40:43], v[4:7]
    ds_read_b128 v[36:39], v157 offset:12800
    s_waitcnt lgkmcnt(5)
    v_mfma_f32_16x16x32_bf16 v[4:7], v[44:47], v[48:51], v[4:7]
    ds_read_b128 v[44:47], v157 offset:19200
    s_waitcnt lgkmcnt(4)
    v_mfma_f32_16x16x32_bf16 v[4:7], v[52:55], v[56:59], v[4:7]
    ds_read_b64 v[52:53], v158 offset:0
    ds_read_b64 v[54:55], v158 offset:12800
    s_waitcnt vmcnt(0) lgkmcnt(0)
    s_barrier
    ds_read_b128 v[24:27], v159 offset:20480
    ds_read_b128 v[32:35], v159 offset:22528
    ds_read_b128 v[40:43], v159 offset:30720
    ds_read_b128 v[48:51], v159 offset:32768
    ds_read_b64 v[56:57], v160 offset:24576
    ds_read_b64 v[58:59], v160 offset:34816
    s_waitcnt lgkmcnt(5)
    v_mfma_f32_16x16x32_bf16 v[8:11], v[20:23], v[24:27], 0
    ds_read_b128 v[20:23], v157 offset:25600
    s_waitcnt lgkmcnt(5)
    v_mfma_f32_16x16x32_bf16 v[8:11], v[28:31], v[32:35], v[8:11]
    ds_read_b128 v[28:31], v157 offset:32000
    s_waitcnt lgkmcnt(5)
    v_mfma_f32_16x16x32_bf16 v[8:11], v[36:39], v[40:43], v[8:11]
    ds_read_b128 v[36:39], v157 offset:38400
    s_waitcnt lgkmcnt(5)
    v_mfma_f32_16x16x32_bf16 v[8:11], v[44:47], v[48:51], v[8:11]
    ds_read_b128 v[44:47], v157 offset:44800
    s_waitcnt lgkmcnt(4)
    v_mfma_f32_16x16x32_bf16 v[8:11], v[52:55], v[56:59], v[8:11]
    ds_read_b64 v[52:53], v158 offset:25600
    ds_read_b64 v[54:55], v158 offset:38400
    v_cmp_u_f32 s[48:49], v4, v4
    v_cvt_pk_bf16_f32 v12, v4, v5
    v_cvt_pk_bf16_f32 v13, v6, v7
    ds_bpermute_b32 v12, v163, v12
    ds_bpermute_b32 v13, v163, v13
    s_barrier
    ds_read_b128 v[24:27], v159 offset:40960
    ds_read_b128 v[32:35], v159 offset:43008
    ds_read_b128 v[40:43], v159 offset:51200
    ds_read_b128 v[48:51], v159 offset:53248
    ds_read_b64 v[56:57], v160 offset:45056
    ds_read_b64 v[58:59], v160 offset:55296
    v_add_u32 v157, s74, v157
    v_add_u32 v158, s74, v158
    s_waitcnt lgkmcnt(5)
    v_mfma_f32_16x16x32_bf16 v[8:11], v[20:23], v[24:27], v[8:11]
    ds_read_b128 v[20:23], v157 offset:0
    s_waitcnt lgkmcnt(5)
    v_mfma_f32_16x16x32_bf16 v[8:11], v[28:31], v[32:35], v[8:11]
    ds_read_b128 v[28:31], v157 offset:6400
    s_waitcnt lgkmcnt(5)
    v_mfma_f32_16x16x32_bf16 v[8:11], v[36:39], v[40:43], v[8:11]
    ds_read_b128 v[36:39], v157 offset:12800
    s_waitcnt lgkmcnt(5)
    v_mfma_f32_16x16x32_bf16 v[8:11], v[44:47], v[48:51], v[8:11]
    ds_read_b128 v[44:47], v157 offset:19200
    s_waitcnt lgkmcnt(4)
    v_mfma_f32_16x16x32_bf16 v[8:11], v[52:55], v[56:59], v[8:11]
    ds_read_b64 v[52:53], v158 offset:0
    ds_read_b64 v[54:55], v158 offset:12800
    s_barrier
    ds_read_b128 v[24:27], v159 offset:0
    ds_read_b128 v[32:35], v159 offset:2048
    ds_read_b128 v[40:43], v159 offset:10240
    ds_read_b128 v[48:51], v159 offset:12288
    ds_read_b64 v[56:57], v160 offset:4096
    ds_read_b64 v[58:59], v160 offset:14336
    s_waitcnt lgkmcnt(5)
    v_mfma_f32_16x16x32_bf16 v[8:11], v[20:23], v[24:27], v[8:11]
    ds_read_b128 v[20:23], v157 offset:25600
    s_waitcnt lgkmcnt(5)
    v_mfma_f32_16x16x32_bf16 v[8:11], v[28:31], v[32:35], v[8:11]
    ds_read_b128 v[28:31], v157 offset:32000
    s_waitcnt lgkmcnt(5)
    v_mfma_f32_16x16x32_bf16 v[8:11], v[36:39], v[40:43], v[8:11]
    ds_read_b128 v[36:39], v157 offset:38400
    s_waitcnt lgkmcnt(5)
    v_mfma_f32_16x16x32_bf16 v[8:11], v[44:47], v[48:51], v[8:11]
    ds_read_b128 v[44:47], v157 offset:44800
    s_waitcnt lgkmcnt(4)
    v_mfma_f32_16x16x32_bf16 v[8:11], v[52:55], v[56:59], v[8:11]
    ds_read_b64 v[52:53], v158 offset:25600
    ds_read_b64 v[54:55], v158 offset:38400
    s_barrier
    s_mov_b32 s8, -102400
    v_add_u32 v159, s8, v159
    v_add_u32 v160, s8, v160
    ds_read_b128 v[24:27], v159 offset:0
    ds_read_b128 v[32:35], v159 offset:2048
    ds_read_b128 v[40:43], v159 offset:10240
    ds_read_b128 v[48:51], v159 offset:12288
    ds_read_b64 v[56:57], v160 offset:4096
    ds_read_b64 v[58:59], v160 offset:14336
    buffer_store_dwordx2 v[12:13], v161, s[44:47], s80 offen offset:1408 nt
    s_waitcnt lgkmcnt(5)
    v_mfma_f32_16x16x32_bf16 v[8:11], v[20:23], v[24:27], v[8:11]
    s_waitcnt lgkmcnt(4)
    v_mfma_f32_16x16x32_bf16 v[8:11], v[28:31], v[32:35], v[8:11]
    s_waitcnt lgkmcnt(3)
    v_mfma_f32_16x16x32_bf16 v[8:11], v[36:39], v[40:43], v[8:11]
    s_waitcnt lgkmcnt(2)
    v_mfma_f32_16x16x32_bf16 v[8:11], v[44:47], v[48:51], v[8:11]
    s_waitcnt lgkmcnt(0)
    v_mfma_f32_16x16x32_bf16 v[8:11], v[52:55], v[56:59], v[8:11]
    s_nop 7
    v_cmp_u_f32 s[50:51], v8, v8
    v_cvt_pk_bf16_f32 v14, v8, v9
    v_cvt_pk_bf16_f32 v15, v10, v11
    ds_bpermute_b32 v14, v163, v14
    ds_bpermute_b32 v15, v163, v15
    s_waitcnt lgkmcnt(0)
    buffer_store_dwordx2 v[14:15], v161, s[44:47], s80 offen offset:128 nt
    s_or_b64 vcc, s[48:49], s[50:51]
    s_cbranch_scc1 TLz_redo
TLz_end:
    s_endpgm
TLz_redo:
    v_add_u32 v157, s75, v157
    v_add_u32 v158, s75, v158
    v_lshlrev_b32 v100, 2, v0
    s_lshl_b32 s52, s4, 7
    s_add_u32 s52, s52, 7569408
    s_mul_i32 s13, s4, 81920
    s_mul_i32 s53, s5, 102400
    s_add_u32 s53, s53, 8421376
    s_mov_b32 s54, 0
TLz_rj:
    s_mov_b32 exec_lo, 0xff
    s_mov_b32 exec_hi, 0x0
    s_mov_b32 s9, 0
Lpoll_7:
    buffer_load_dword v101, v100, s[40:43], s52 offen sc1
    s_add_u32 s9, s9, 1
    s_waitcnt vmcnt(0)
    v_cmp_ne_u32 vcc, s96, v101
    s_cmp_gt_u32 s9, 131072
    s_cbranch_scc1 Lpd_8
    s_cbranch_vccz Lpd_8
    s_sleep 1
    s_branch Lpoll_7
Lpd_8:
    s_mov_b64 exec, -1
    v_mov_b32 v4, 0
    v_mov_b32 v5, 0
    v_mov_b32 v6, 0
    v_mov_b32 v7, 0
    s_add_u32 s69, s5, s4
    s_mov_b32 s56, 0
TLz_rl:
    s_and_b32 s69, s69, 3
    s_mul_i32 s8, s69, 20480
    s_add_u32 s8, s8, s13
    s_add_u32 s9, s8, 4096
    s_add_u32 s10, s8, 10240
    s_add_u32 s11, s8, 14336
    s_mul_i32 s12, s69, 25600
    s_add_u32 s12, s12, s53
    buffer_load_dwordx4 v[24:27], v159, s[40:43], s8 offen offset:0 sc1
    s_add_u32 s14, s12, 0
    buffer_load_dwordx4 v[20:23], v157, s[40:43], s14 offen sc1
    buffer_load_dwordx4 v[32:35], v159, s[40:43], s8 offen offset:2048 sc1
    s_add_u32 s14, s12, 6400
    buffer_load_dwordx4 v[28:31], v157, s[40:43], s14 offen sc1
    buffer_load_dwordx4 v[40:43], v159, s[40:43], s10 offen offset:0 sc1
    s_add_u32 s14, s12, 12800
    buffer_load_dwordx4 v[36:39], v157, s[40:43], s14 offen sc1
    buffer_load_dwordx4 v[48:51], v159, s[40:43], s10 offen offset:2048 sc1
    s_add_u32 s14, s12, 19200
    buffer_load_dwordx4 v[44:47], v157, s[40:43], s14 offen sc1
    buffer_load_dwordx2 v[56:57], v160, s[40:43], s9 offen sc1
    s_add_u32 s14, s12, 0
    buffer_load_dwordx2 v[52:53], v158, s[40:43], s14 offen sc1
    buffer_load_dwordx2 v[58:59], v160, s[40:43], s11 offen sc1
    s_add_u32 s14, s12, 12800
    buffer_load_dwordx2 v[54:55], v158, s[40:43], s14 offen sc1
    s_waitcnt vmcnt(0)
    v_mfma_f32_16x16x32_bf16 v[4:7], v[20:23], v[24:27], v[4:7]
    v_mfma_f32_16x16x32_bf16 v[4:7], v[28:31], v[32:35], v[4:7]
    v_mfma_f32_16x16x32_bf16 v[4:7], v[36:39], v[40:43], v[4:7]
    v_mfma_f32_16x16x32_bf16 v[4:7], v[44:47], v[48:51], v[4:7]
    v_mfma_f32_16x16x32_bf16 v[4:7], v[52:55], v[56:59], v[4:7]
    s_add_u32 s69, s69, 1
    s_add_u32 s56, s56, 1
    s_cmp_lt_u32 s56, 4
    s_cbranch_scc1 TLz_rl
    s_nop 11
    v_cvt_pk_bf16_f32 v132, v4, v5
    v_cvt_pk_bf16_f32 v133, v6, v7
    ds_bpermute_b32 v132, v163, v132
    ds_bpermute_b32 v133, v163, v133
    s_waitcnt lgkmcnt(0)
    buffer_store_dwordx2 v[132:133], v161, s[44:47], s80 offen offset:128 nt
    s_add_u32 s80, s80, 1280
    s_add_u32 s81, s81, 1280
    s_add_u32 s13, s13, 2621440
    s_sub_u32 s52, s52, 32768
    s_sub_u32 s53, s53, 819200
    s_add_u32 s54, s54, 1
    s_cmp_lt_u32 s54, 2
    s_cbranch_scc1 TLz_rj
    s_branch TLz_end
AT_fallback:
    s_mov_b32 exec_lo, 0
    v_mov_b32 v50, 0
    v_mov_b32 v51, 0
    s_mov_b32 exec_lo, -1
    v_mov_b32 v80, 0xff800000
    s_mov_b32 s70, 5126144
AT_fb1:
    buffer_load_dwordx4 v[44:47], v136, s[40:43], s70 offen sc1
    buffer_load_dwordx2 v[48:49], v137, s[40:43], s70 offen sc1
    s_waitcnt vmcnt(0)
    v_mfma_f32_32x32x16_bf16 v[4:19], v[44:47], v[60:63], 0
    v_mfma_f32_32x32x8_bf16 v[4:19], v[48:49], v[50:51], v[4:19]
    s_nop 15
    v_max3_f32 v80, v80, v4, v5
    v_max3_f32 v80, v80, v6, v7
    v_max3_f32 v80, v80, v8, v9
    v_max3_f32 v80, v80, v10, v11
    v_max3_f32 v80, v80, v12, v13
    v_max3_f32 v80, v80, v14, v15
    v_max3_f32 v80, v80, v16, v17
    v_max3_f32 v80, v80, v18, v19
    s_add_u32 s70, s70, 2816
    s_cmp_lt_u32 s70, 5306368
    s_cbranch_scc1 AT_fb1
    v_mov_b32 v81, v80
    s_nop 1
    v_permlane32_swap_b32 v80, v81
    s_nop 1
    v_max_f32 v82, v80, v81
    s_mov_b32 exec_lo, 0
    v_sub_f32 v80, 0, v82
    v_and_b32 v81, 0xffff0000, v80
    v_sub_f32 v80, v80, v81
    v_lshrrev_b32 v50, 16, v81
    v_and_b32 v81, 0xffff0000, v80
    v_sub_f32 v80, v80, v81
    v_or_b32 v50, v50, v81
    v_lshrrev_b32 v51, 16, v80
    s_mov_b32 exec_lo, -1
    v_mov_b32 v64, 0
    v_mov_b32 v65, 0
    v_mov_b32 v66, 0
    v_mov_b32 v67, 0
    v_mov_b32 v68, 0
    v_mov_b32 v69, 0
    v_mov_b32 v70, 0
    v_mov_b32 v71, 0
    v_mov_b32 v72, 0
    v_mov_b32 v73, 0
    v_mov_b32 v74, 0
    v_mov_b32 v75, 0
    v_mov_b32 v76, 0
    v_mov_b32 v77, 0
    v_mov_b32 v78, 0
    v_mov_b32 v79, 0
    s_mov_b32 s70, 5126144
AT_fb2:
    buffer_load_dwordx4 v[44:47], v136, s[40:43], s70 offen sc1
    buffer_load_dwordx2 v[48:49], v137, s[40:43], s70 offen sc1
    buffer_load_dwordx4 v[52:55], v138, s[40:43], s70 offen sc1
    buffer_load_dwordx4 v[56:59], v139, s[40:43], s70 offen sc1
    s_waitcnt vmcnt(0)
    v_mfma_f32_32x32x16_bf16 v[4:19], v[44:47], v[60:63], 0
    v_mfma_f32_32x32x8_bf16 v[4:19], v[48:49], v[50:51], v[4:19]
    s_nop 15
    v_exp_f32 v4, v4
    v_exp_f32 v5, v5
    v_exp_f32 v6, v6
    v_exp_f32 v7, v7
    v_exp_f32 v8, v8
    v_exp_f32 v9, v9
    v_exp_f32 v10, v10
    v_exp_f32 v11, v11
    v_exp_f32 v36, v12
    v_exp_f32 v37, v13
    v_exp_f32 v38, v14
    v_exp_f32 v39, v15
    v_exp_f32 v40, v16
    v_exp_f32 v41, v17
    v_exp_f32 v42, v18
    v_exp_f32 v43, v19
    s_nop 1
    v_smfmac_f32_32x32x32_bf16 v[64:79], v[52:55], v[4:11], v167
    v_smfmac_f32_32x32x32_bf16 v[64:79], v[56:59], v[36:43], v167
    s_add_u32 s70, s70, 2816
    s_cmp_lt_u32 s70, 5306368
    s_cbranch_scc1 AT_fb2
    s_nop 15
    s_branch AT_ok
L_md:
    s_and_b32 s8, s5, 1
    s_mul_i32 s8, s8, 5
    s_and_b32 s9, s5, 2
    s_add_u32 s8, s8, s9
    s_and_b32 s9, s4, 7
    s_add_u32 s11, s8, s9
    s_cmp_ge_u32 s11, 10
    s_cselect_b32 s8, 10, 0
    s_sub_u32 s11, s11, s8
    s_mov_b32 s12, 0
    s_lshl_b32 s8, s10, 2
    s_lshl_b32 s9, s10, 3
    v_lshrrev_b32 v20, 4, v0
    v_add_u32 v20, s8, v20
    v_xor_b32 v20, v20, v0
    v_and_b32 v20, 7, v20
    v_lshlrev_b32 v20, 4, v20
    v_lshrrev_b32 v21, 3, v0
    v_add_u32 v21, s9, v21
    v_mul_u32_u24 v21, 1280, v21
    v_add_u32 v2, v20, v21
    s_mov_b32 s8, 1120
    v_add_u32 v20, 0, v0
    v_mul_u32_u24 v22, 6554, v20
    v_lshrrev_b32 v22, 16, v22
    v_lshlrev_b32 v20, 4, v20
    v_mad_u32_u24 v3, v22, s8, v20
    v_add_u32 v20, 64, v0
    v_mul_u32_u24 v23, 6554, v20
    v_lshrrev_b32 v23, 16, v23
    v_lshlrev_b32 v20, 4, v20
    v_mad_u32_u24 v4, v23, s8, v20
    v_add_u32 v20, 128, v0
    v_mul_u32_u24 v24, 6554, v20
    v_lshrrev_b32 v24, 16, v24
    v_lshlrev_b32 v20, 4, v20
    v_mad_u32_u24 v5, v24, s8, v20
    v_add_u32 v20, 192, v0
    v_mul_u32_u24 v25, 6554, v20
    v_lshrrev_b32 v25, 16, v25
    v_lshlrev_b32 v20, 4, v20
    v_mad_u32_u24 v6, v25, s8, v20
    v_add_u32 v20, 256, v0
    v_mul_u32_u24 v26, 6554, v20
    v_lshrrev_b32 v26, 16, v26
    v_lshlrev_b32 v20, 4, v20
    v_mad_u32_u24 v7, v26, s8, v20
    s_mul_i32 s64, s5, 160
    s_mul_i32 s65, s10, 40960
    s_add_u32 s65, s65, s64
    s_mov_b32 s48, s18
    s_mov_b32 s49, s19
    s_mov_b32 s50, 819200
    s_mov_b32 s51, 0x20000
    s_call_b64 s[62:63], L_issueA
    s_waitcnt vmcnt(9)
    s_barrier
    s_call_b64 s[62:63], L_issueA
    s_call_b64 s[62:63], L_issueA
    s_mov_b32 s70, 0
L_a:
    s_waitcnt vmcnt(18)
    s_barrier
    s_call_b64 s[62:63], L_issueA
    s_add_u32 s70, s70, 1
    s_cmp_lt_u32 s70, 7
    s_cbranch_scc1 L_a
    s_mov_b32 s40, s36
    s_mov_b32 s41, s37
    s_mov_b32 s42, 14680064
    s_mov_b32 s43, 0x20000
    s_mov_b32 s72, s26
    s_mov_b32 s73, s27
    s_mov_b32 s74, 2621440
    s_mov_b32 s75, 0x20000
    s_mov_b32 s76, s28
    s_mov_b32 s77, s29
    s_mov_b32 s78, 2457600
    s_mov_b32 s79, 0x20000
    s_waitcnt vmcnt(18)
    s_barrier
    s_mov_b32 s8, 2560
    s_mov_b32 s9, 1280
    v_mad_u32_u24 v8, v22, s8, v3
    v_lshrrev_b32 v20, 1, v22
    v_mad_u32_u24 v13, v20, s9, v3
    v_mad_u32_u24 v9, v23, s8, v4
    v_lshrrev_b32 v20, 1, v23
    v_mad_u32_u24 v14, v20, s9, v4
    v_mad_u32_u24 v10, v24, s8, v5
    v_lshrrev_b32 v20, 1, v24
    v_mad_u32_u24 v15, v20, s9, v5
    v_mad_u32_u24 v11, v25, s8, v6
    v_lshrrev_b32 v20, 1, v25
    v_mad_u32_u24 v16, v20, s9, v6
    v_mad_u32_u24 v12, v26, s8, v7
    v_lshrrev_b32 v20, 1, v26
    v_mad_u32_u24 v17, v20, s9, v7
    s_mul_i32 s66, s10, 122880
    s_add_u32 s66, s66, s64
    s_add_u32 s67, s66, 1280
    v_mov_b32 v31, 163824
    ds_read_b32 v30, v31
    s_waitcnt lgkmcnt(0)
    v_readfirstlane_b32 s96, v30
    s_waitcnt vmcnt(9)
    s_barrier
    s_waitcnt vmcnt(0)
    s_barrier
    s_mov_b32 s12, 0
    s_add_u32 s69, s5, s4
    s_and_b32 s69, s69, 3
    s_cmp_eq_u32 s10, 1
    s_cbranch_scc1 L1_path
    s_add_u32 s60, s7, 4
    s_and_b32 s60, s60, 15
    s_mov_b32 s61, 116736
    s_lshl_b32 s56, s4, 7
    s_lshl_b32 s57, s5, 2
    s_add_u32 s57, s57, s56
    v_lshlrev_b32 v19, 2, v0
    v_mov_b32 v33, 163824
    s_barrier
    s_call_b64 s[62:63], L_issueB1
    s_barrier
    s_call_b64 s[62:63], L_issueB2
    s_mov_b32 s9, 0
L0_c0:
    ds_read_b32 v32, v33 offset:4
    s_add_u32 s9, s9, 1
    s_waitcnt lgkmcnt(0)
    v_readfirstlane_b32 s8, v32
    s_cmp_gt_u32 s9, 131072
    s_cbranch_scc1 L0_c1
    s_cmp_ge_u32 s8, 8
    s_cbranch_scc1 L0_c1
    s_sleep 2
    s_branch L0_c0
L0_c1:
    s_call_b64 s[62:63], L_issueKV
    s_call_b64 s[62:63], L_issueB1
    s_waitcnt vmcnt(20)
    s_barrier
    s_call_b64 s[62:63], L_issueB2
    s_call_b64 s[62:63], L_issueB1
    s_call_b64 s[62:63], L_issueKV
    s_waitcnt vmcnt(20)
    s_barrier
    s_call_b64 s[62:63], L_issueB2
    s_call_b64 s[62:63], L_issueB
    s_call_b64 s[62:63], L_issueKV
    s_waitcnt vmcnt(30)
    s_barrier
    s_call_b64 s[62:63], L_issueB
    s_call_b64 s[62:63], L_issueKV
    s_waitcnt vmcnt(30)
    s_barrier
    s_call_b64 s[62:63], L_issueB
    s_waitcnt vmcnt(30)
    s_barrier
    s_call_b64 s[62:63], L_issueB
    s_call_b64 s[62:63], L_issueKV
    s_waitcnt vmcnt(30)
    s_barrier
    s_call_b64 s[62:63], L_issueB
    s_call_b64 s[62:63], L_issueKV
    s_waitcnt vmcnt(41)
    s_barrier
    s_call_b64 s[62:63], L_issueB
    s_waitcnt vmcnt(30)
    s_barrier
    s_call_b64 s[62:63], L_issueB
    s_call_b64 s[62:63], L_issueKV
    s_waitcnt vmcnt(30)
    s_barrier
    s_waitcnt vmcnt(11)
    s_barrier
    s_call_b64 s[62:63], L_issueKV
    s_mov_b32 s12, 0
    s_mul_i32 s64, s5, 102400
    s_add_u32 s64, s64, 7602176
    s_barrier
    s_call_b64 s[62:63], L_issueWo
    s_waitcnt vmcnt(25)
    s_barrier
    s_call_b64 s[62:63], L_issueKV
    s_waitcnt vmcnt(0)
    s_barrier
    s_call_b64 s[62:63], L_issueKV
    s_call_b64 s[62:63], L_issueWo
    s_waitcnt vmcnt(25)
    s_barrier
    s_call_b64 s[62:63], L_issueKV
    s_waitcnt vmcnt(0)
    s_barrier
    s_call_b64 s[62:63], L_issueKV
    s_mov_b32 s9, 0
L0_d0:
    ds_read_b32 v32, v33 offset:8
    s_add_u32 s9, s9, 1
    s_waitcnt lgkmcnt(0)
    v_readfirstlane_b32 s8, v32
    s_cmp_gt_u32 s9, 131072
    s_cbranch_scc1 L0_d1
    s_cmp_ge_u32 s8, 8
    s_cbranch_scc1 L0_d1
    s_sleep 2
    s_branch L0_d0
L0_d1:
    s_add_u32 s8, s57, 7520256
    v_mov_b32 v30, s96
    v_mov_b32 v31, 0
    s_mov_b64 exec, 1
    buffer_store_dword v30, v31, s[40:43], s8 offen sc1
    s_mov_b64 exec, -1
    s_call_b64 s[62:63], L_issueWo
    s_call_b64 s[62:63], L_issueWo
    s_waitcnt vmcnt(51)
    s_barrier
    s_add_u32 s13, s13, 2621440
    s_mov_b32 s61, 102400
    s_add_u32 s8, s56, 7520256
    s_mov_b32 exec_lo, 0xff
    s_mov_b32 exec_hi, 0x0
    s_mov_b32 s9, 0
Lpoll_9:
    buffer_load_dword v30, v19, s[40:43], s8 offen sc1
    s_add_u32 s9, s9, 1
    s_waitcnt vmcnt(0)
    v_cmp_ne_u32 vcc, s96, v30
    s_cmp_gt_u32 s9, 131072
    s_cbranch_scc1 Lpd_10
    s_cbranch_vccz Lpd_10
    s_sleep 1
    s_branch Lpoll_9
Lpd_10:
    s_mov_b64 exec, -1
    s_call_b64 s[62:63], L_issueP
    s_call_b64 s[62:63], L_issuePa
    s_barrier
    s_call_b64 s[62:63], L_issuePb
    s_add_u32 s70, s57, 7503872
    s_add_u32 s71, s56, 7503872
    s_waitcnt vmcnt(20)
    s_barrier
    v_mov_b32 v30, s96
    v_mov_b32 v31, 0
    s_mov_b64 exec, 1
    buffer_store_dword v30, v31, s[40:43], s70 offen sc1
    s_mov_b64 exec, -1
    s_call_b64 s[62:63], L_issueP
    s_waitcnt vmcnt(21)
    s_barrier
    s_call_b64 s[62:63], L_issueP
    s_sub_u32 s13, s13, 2621440
    s_mov_b32 exec_lo, 0xff
    s_mov_b32 exec_hi, 0x0
    buffer_load_dword v32, v19, s[40:43], s71 offen sc1
    s_mov_b64 exec, -1
    s_waitcnt vmcnt(21)
    s_barrier
    s_mov_b32 exec_lo, 0xff
    s_mov_b32 exec_hi, 0x0
    s_waitcnt vmcnt(0)
    v_cmp_ne_u32 vcc, s96, v32
    s_nop 1
    s_cbranch_vccz L0_go
    buffer_load_dword v32, v19, s[40:43], s71 offen sc1
    s_waitcnt vmcnt(0)
    v_cmp_ne_u32 vcc, s96, v32
    s_mov_b64 exec, -1
    s_cbranch_vccnz L0_late
L0_go:
    s_mov_b64 exec, -1
    s_call_b64 s[62:63], L_issueP
    s_barrier
    s_branch L0_join
L0_late:
    s_barrier
    s_mov_b32 exec_lo, 0xff
    s_mov_b32 exec_hi, 0x0
    s_mov_b32 s9, 0
Lpoll_11:
    buffer_load_dword v30, v19, s[40:43], s71 offen sc1
    s_add_u32 s9, s9, 1
    s_waitcnt vmcnt(0)
    v_cmp_ne_u32 vcc, s96, v30
    s_cmp_gt_u32 s9, 131072
    s_cbranch_scc1 Lpd_12
    s_cbranch_vccz Lpd_12
    s_sleep 1
    s_branch Lpoll_11
Lpd_12:
    s_mov_b64 exec, -1
    s_call_b64 s[62:63], L_issueP
L0_join:
    s_call_b64 s[62:63], L_issueP
    s_waitcnt vmcnt(20)
    s_barrier
    s_call_b64 s[62:63], L_issueP
    s_waitcnt vmcnt(20)
    s_barrier
    s_waitcnt vmcnt(0)
    s_barrier
    s_waitcnt vmcnt(0)
    s_barrier
    s_endpgm
L1_path:
    s_mov_b32 s48, s24
    s_mov_b32 s49, s25
    s_mov_b32 s50, 819200
    s_mov_b32 s51, 0x20000
    s_mov_b32 s52, s30
    s_mov_b32 s53, s31
    s_mov_b32 s54, 819200
    s_mov_b32 s55, 0x20000
    s_lshl_b32 s56, s5, 5
    s_add_u32 s57, s56, s4
    s_mul_i32 s68, s57, 6784
    s_add_u32 s68, s68, 10485760
    s_lshl_b32 s56, s5, 9
    s_lshr_b32 s8, s4, 3
    s_lshl_b32 s8, s8, 7
    s_and_b32 s57, s4, 7
    s_lshl_b32 s57, s57, 2
    s_add_u32 s57, s57, s8
    s_add_u32 s57, s57, s56
    v_lshrrev_b32 v19, 3, v0
    v_lshlrev_b32 v19, 7, v19
    v_and_b32 v28, 7, v0
    v_lshl_add_u32 v19, v28, 2, v19
    v_lshrrev_b32 v48, 4, v0
    v_mul_u32_u24 v48, 54272, v48
    v_and_b32 v49, 15, v0
    v_min_u32 v47, 13, v49
    v_lshl_add_u32 v48, v47, 4, v48
    v_lshlrev_b32 v49, 3, v49
    v_lshlrev_b32 v46, 7, v0
    v_mov_b32 v52, -1
    v_mov_b32 v53, -1
    v_mov_b32 v54, -1
    v_mov_b32 v55, -1
    v_bfe_u32 v20, v0, 2, 2
    v_mul_u32_u24 v20, 160, v20
    v_and_b32 v21, 3, v0
    v_lshl_add_u32 v20, v21, 3, v20
    v_add_u32 v20, 106496, v20
    v_lshrrev_b32 v21, 5, v0
    v_bfe_u32 v28, v0, 4, 1
    v_mul_u32_u24 v41, 1280, v21
    v_lshl_add_u32 v41, v28, 5, v41
    v_add_u32 v41, v41, v20
    v_mul_u32_u24 v42, 1280, v28
    v_add_u32 v42, v42, v20
    v_lshrrev_b32 v21, 4, v0
    v_lshl_add_u32 v43, v21, 5, v20
    v_lshlrev_b32 v44, 3, v0
    s_barrier
    s_call_b64 s[62:63], L_issueB1
    s_barrier
    s_call_b64 s[62:63], L_issueB2
    s_mov_b32 m0, 106496
    s_mul_i32 s8, s4, 25600
    s_add_u32 s8, s8, s64
    buffer_load_dwordx4 v3, s[52:55], s8 offen  lds
    s_add_u32 m0, m0, 1024
    s_nop 0
    buffer_load_dwordx4 v4, s[52:55], s8 offen  lds
    s_add_u32 m0, m0, 1024
    s_nop 0
    buffer_load_dwordx4 v5, s[52:55], s8 offen  lds
    s_add_u32 m0, m0, 1024
    s_nop 0
    buffer_load_dwordx4 v6, s[52:55], s8 offen  lds
    s_add_u32 m0, m0, 1024
    s_nop 0
    buffer_load_dwordx4 v3, s[48:51], s8 offen  lds
    s_add_u32 m0, m0, 1024
    s_nop 0
    buffer_load_dwordx4 v4, s[48:51], s8 offen  lds
    s_add_u32 m0, m0, 1024
    s_nop 0
    buffer_load_dwordx4 v5, s[48:51], s8 offen  lds
    s_add_u32 m0, m0, 1024
    s_nop 0
    buffer_load_dwordx4 v6, s[48:51], s8 offen  lds
    s_add_u32 m0, m0, 1024
    s_nop 0
    s_call_b64 s[62:63], L_issueB1
    s_waitcnt vmcnt(17)
    s_barrier
    s_call_b64 s[62:63], L_issueB2
    s_waitcnt vmcnt(19)
    ds_read_b64_tr_b16 v[100:101], v41 offset:0
    ds_read_b64_tr_b16 v[102:103], v41 offset:640
    ds_read_b64_tr_b16 v[104:105], v41 offset:64
    ds_read_b64_tr_b16 v[106:107], v41 offset:704
    ds_read_b64_tr_b16 v[108:109], v42 offset:128
    ds_read_b64_tr_b16 v[110:111], v42 offset:768
    ds_read_b64_tr_b16 v[112:113], v43 offset:2560
    ds_read_b64_tr_b16 v[114:115], v43 offset:2688
    ds_read_b64_tr_b16 v[116:117], v41 offset:4096
    ds_read_b64_tr_b16 v[118:119], v41 offset:4736
    ds_read_b64_tr_b16 v[120:121], v41 offset:4160
    ds_read_b64_tr_b16 v[122:123], v41 offset:4800
    ds_read_b64_tr_b16 v[124:125], v42 offset:4224
    ds_read_b64_tr_b16 v[126:127], v42 offset:4864
    ds_read_b64_tr_b16 v[128:129], v43 offset:6656
    ds_read_b64_tr_b16 v[130:131], v43 offset:6784
    s_waitcnt lgkmcnt(0)
    s_call_b64 s[62:63], L_issueB1
    s_waitcnt vmcnt(9)
    s_barrier
    s_call_b64 s[62:63], L_issueB2
    s_call_b64 s[62:63], L_issueB
    s_waitcnt vmcnt(19)
    s_barrier
    s_call_b64 s[62:63], L_issueB
    s_mul_i32 s64, s5, 102400
    s_mul_i32 s8, s4, 3200
    s_add_u32 s8, s8, s64
    s_add_u32 s9, s8, 8421376
    s_add_u32 s8, s8, 7602176
    s_add_u32 s64, s64, 8421376
    buffer_store_dwordx4 v[100:103], v18, s[40:43], s8 offen sc1
    buffer_store_dwordx4 v[104:107], v18, s[40:43], s8 offen offset:1024 sc1
    buffer_store_dwordx2 v[112:113], v44, s[40:43], s8 offen offset:2560 sc1
    buffer_store_dwordx4 v[116:119], v18, s[40:43], s9 offen sc1
    buffer_store_dwordx4 v[120:123], v18, s[40:43], s9 offen offset:1024 sc1
    buffer_store_dwordx2 v[128:129], v44, s[40:43], s9 offen offset:2560 sc1
    s_mov_b32 exec_lo, 0xffffffff
    s_mov_b32 exec_hi, 0x0
    buffer_store_dwordx4 v[108:111], v18, s[40:43], s8 offen offset:2048 sc1
    buffer_store_dwordx4 v[124:127], v18, s[40:43], s9 offen offset:2048 sc1
    s_mov_b32 exec_lo, 0xffff
    s_mov_b32 exec_hi, 0x0
    buffer_store_dwordx2 v[114:115], v44, s[40:43], s8 offen offset:3072 sc1
    buffer_store_dwordx2 v[130:131], v44, s[40:43], s9 offen offset:3072 sc1
    s_mov_b64 exec, -1
    s_waitcnt vmcnt(29)
    s_barrier
    s_call_b64 s[62:63], L_issueB
    s_lshl_b32 s60, s5, 12
    s_add_u32 s60, s60, 7340032
    s_mul_i32 s61, s4, 112
    s_add_u32 s61, s61, s60
    s_mov_b32 exec_lo, 0x3fff
    s_mov_b32 exec_hi, 0x0
    buffer_store_dwordx2 v[52:53], v49, s[40:43], s61 offen sc1
    s_add_u32 s65, s68, 4096
    s_mov_b32 exec_lo, 0xffffffff
    s_mov_b32 exec_hi, 0xff
    buffer_store_dwordx4 v[52:55], v18, s[40:43], s65 offen offset:2048 sc1
    s_mov_b64 exec, -1
    buffer_store_dwordx4 v[52:55], v18, s[40:43], s68 offen offset:0 sc1
    buffer_store_dwordx4 v[52:55], v18, s[40:43], s68 offen offset:1024 sc1
    buffer_store_dwordx4 v[52:55], v18, s[40:43], s68 offen offset:2048 sc1
    buffer_store_dwordx4 v[52:55], v18, s[40:43], s68 offen offset:3072 sc1
    buffer_store_dwordx4 v[52:55], v18, s[40:43], s65 offen offset:0 sc1
    buffer_store_dwordx4 v[52:55], v18, s[40:43], s65 offen offset:1024 sc1
    s_waitcnt vmcnt(37)
    s_barrier
    s_call_b64 s[62:63], L_issueB
    s_waitcnt vmcnt(19)
    s_barrier
    s_add_u32 s8, s57, 7471104
    v_mov_b32 v30, s96
    v_mov_b32 v31, 0
    s_mov_b64 exec, 1
    buffer_store_dword v30, v31, s[40:43], s8 offen sc1
    s_mov_b64 exec, -1
    s_call_b64 s[62:63], L_issueB
    s_waitcnt vmcnt(20)
    s_barrier
    s_call_b64 s[62:63], L_issueB
    s_waitcnt vmcnt(19)
    s_barrier
    s_call_b64 s[62:63], L_issueB
    s_waitcnt vmcnt(19)
    s_barrier
    s_mul_i32 s8, s5, 10240
    s_add_u32 s8, s8, s13
    s_add_u32 s8, s8, 0
    buffer_store_dwordx4 v[52:55], v18, s[40:43], s8 offen offset:0 sc1
    buffer_store_dwordx4 v[52:55], v18, s[40:43], s8 offen offset:1024 sc1
    buffer_store_dwordx4 v[52:55], v18, s[40:43], s8 offen offset:2048 sc1
    buffer_store_dwordx4 v[52:55], v18, s[40:43], s8 offen offset:3072 sc1
    s_add_u32 s8, s8, 4096
    buffer_store_dwordx4 v[52:55], v18, s[40:43], s8 offen offset:0 sc1
    buffer_store_dwordx4 v[52:55], v18, s[40:43], s8 offen offset:1024 sc1
    buffer_store_dwordx4 v[52:55], v18, s[40:43], s8 offen offset:2048 sc1
    buffer_store_dwordx4 v[52:55], v18, s[40:43], s8 offen offset:3072 sc1
    s_add_u32 s8, s8, 4096
    buffer_store_dwordx4 v[52:55], v18, s[40:43], s8 offen offset:0 sc1
    buffer_store_dwordx4 v[52:55], v18, s[40:43], s8 offen offset:1024 sc1
    s_mul_i32 s8, s5, 10240
    s_add_u32 s8, s8, s13
    s_add_u32 s8, s8, 2621440
    buffer_store_dwordx4 v[52:55], v18, s[40:43], s8 offen offset:0 sc1
    buffer_store_dwordx4 v[52:55], v18, s[40:43], s8 offen offset:1024 sc1
    buffer_store_dwordx4 v[52:55], v18, s[40:43], s8 offen offset:2048 sc1
    buffer_store_dwordx4 v[52:55], v18, s[40:43], s8 offen offset:3072 sc1
    s_add_u32 s8, s8, 4096
    buffer_store_dwordx4 v[52:55], v18, s[40:43], s8 offen offset:0 sc1
    buffer_store_dwordx4 v[52:55], v18, s[40:43], s8 offen offset:1024 sc1
    buffer_store_dwordx4 v[52:55], v18, s[40:43], s8 offen offset:2048 sc1
    buffer_store_dwordx4 v[52:55], v18, s[40:43], s8 offen offset:3072 sc1
    s_add_u32 s8, s8, 4096
    buffer_store_dwordx4 v[52:55], v18, s[40:43], s8 offen offset:0 sc1
    buffer_store_dwordx4 v[52:55], v18, s[40:43], s8 offen offset:1024 sc1
    s_waitcnt vmcnt(20)
    s_barrier
    s_add_u32 s8, s56, 7471104
    s_mov_b32 exec_lo, 0xffffffff
    s_mov_b32 exec_hi, 0x0
    s_mov_b32 s9, 0
Lpoll_13:
    buffer_load_dword v30, v19, s[40:43], s8 offen sc1
    s_add_u32 s9, s9, 1
    s_waitcnt vmcnt(0)
    v_cmp_ne_u32 vcc, s96, v30
    s_cmp_gt_u32 s9, 131072
    s_cbranch_scc1 Lpd_14
    s_cbranch_vccz Lpd_14
    s_sleep 1
    s_branch Lpoll_13
Lpd_14:
    s_mov_b64 exec, -1
    s_and_b32 s8, s4, 7
    s_mul_i32 s8, s8, 12800
    s_add_u32 s8, s8, s64
    s_mov_b32 exec_hi, 0x3ffff
    s_add_u32 s8, s8, 0
    buffer_load_dword v140, v46, s[40:43], s8 offen sc1
    s_add_u32 s8, s8, 6400
    buffer_load_dword v141, v46, s[40:43], s8 offen sc1
    s_add_u32 s8, s8, -825600
    buffer_load_dword v142, v46, s[40:43], s8 offen sc1
    s_add_u32 s8, s8, 6400
    buffer_load_dword v143, v46, s[40:43], s8 offen sc1
    s_mov_b32 exec_hi, -1
    s_min_u32 s9, s4, 29
    s_mul_i32 s9, s9, 224
    s_mul_i32 s70, s5, 217088
    s_add_u32 s70, s70, s9
    s_add_u32 s70, s70, 10485760
    v_add_u32 v51, 102400, v18
    s_barrier
    s_barrier
    ds_read_b128 v[60:63], v51 offset:0
    ds_read_b128 v[64:67], v51 offset:1024
    ds_read_b128 v[68:71], v51 offset:2048
    ds_read_b128 v[72:75], v51 offset:3072
    ds_read_b128 v[76:79], v51 offset:4096
    ds_read_b128 v[80:83], v51 offset:5120
    ds_read_b128 v[84:87], v51 offset:6144
    s_waitcnt lgkmcnt(6)
    buffer_store_dwordx4 v[60:63], v18, s[40:43], s68 offen offset:0 sc1
    s_waitcnt lgkmcnt(5)
    buffer_store_dwordx4 v[64:67], v18, s[40:43], s68 offen offset:1024 sc1
    s_waitcnt lgkmcnt(4)
    buffer_store_dwordx4 v[68:71], v18, s[40:43], s68 offen offset:2048 sc1
    s_waitcnt lgkmcnt(3)
    buffer_store_dwordx4 v[72:75], v18, s[40:43], s68 offen offset:3072 sc1
    s_waitcnt lgkmcnt(2)
    buffer_store_dwordx4 v[76:79], v18, s[40:43], s65 offen offset:0 sc1
    s_waitcnt lgkmcnt(1)
    buffer_store_dwordx4 v[80:83], v18, s[40:43], s65 offen offset:1024 sc1
    s_waitcnt lgkmcnt(0)
    s_mov_b32 exec_hi, 15
    buffer_store_dwordx4 v[84:87], v18, s[40:43], s65 offen offset:2048 sc1
    s_mov_b32 exec_hi, -1
    s_waitcnt vmcnt(0)
    s_mov_b32 s9, 0
L1_p:
    s_mov_b32 s8, s70
    buffer_load_dwordx4 v[100:103], v48, s[40:43], s8 offen sc1
    s_add_u32 s8, s8, 6784
    buffer_load_dwordx4 v[104:107], v48, s[40:43], s8 offen sc1
    s_add_u32 s8, s8, 6784
    buffer_load_dwordx4 v[108:111], v48, s[40:43], s8 offen sc1
    s_add_u32 s8, s8, 6784
    buffer_load_dwordx4 v[112:115], v48, s[40:43], s8 offen sc1
    s_add_u32 s8, s8, 6784
    buffer_load_dwordx4 v[116:119], v48, s[40:43], s8 offen sc1
    s_add_u32 s8, s8, 6784
    buffer_load_dwordx4 v[120:123], v48, s[40:43], s8 offen sc1
    s_add_u32 s8, s8, 6784
    buffer_load_dwordx4 v[124:127], v48, s[40:43], s8 offen sc1
    s_add_u32 s8, s8, 6784
    buffer_load_dwordx4 v[128:131], v48, s[40:43], s8 offen sc1
    s_add_u32 s8, s8, 6784
    s_cmp_lg_u32 s9, 0
    s_cbranch_scc1 L1_p2
    s_barrier
L1_p2:
    s_add_u32 s9, s9, 1
    s_waitcnt vmcnt(0)
    v_pk_add_f32 v[60:61], v[100:101], v[116:117]
    v_pk_add_f32 v[62:63], v[102:103], v[118:119]
    v_pk_add_f32 v[64:65], v[104:105], v[120:121]
    v_pk_add_f32 v[66:67], v[106:107], v[122:123]
    v_pk_add_f32 v[68:69], v[108:109], v[124:125]
    v_pk_add_f32 v[70:71], v[110:111], v[126:127]
    v_pk_add_f32 v[72:73], v[112:113], v[128:129]
    v_pk_add_f32 v[74:75], v[114:115], v[130:131]
    v_pk_add_f32 v[60:61], v[60:61], v[68:69]
    v_pk_add_f32 v[62:63], v[62:63], v[70:71]
    v_pk_add_f32 v[64:65], v[64:65], v[72:73]
    v_pk_add_f32 v[66:67], v[66:67], v[74:75]
    v_pk_add_f32 v[60:61], v[60:61], v[64:65]
    v_pk_add_f32 v[62:63], v[62:63], v[66:67]
    v_pk_add_f32 v[30:31], v[60:61], v[62:63]
    v_cmp_u_f32 vcc, v30, v31
    s_nop 1
    s_cbranch_vccz L1_pd
    v_max_u32 v30, v100, v101
    v_max3_u32 v30, v30, v102, v103
    v_max3_u32 v30, v30, v104, v105
    v_max3_u32 v30, v30, v106, v107
    v_max3_u32 v30, v30, v108, v109
    v_max3_u32 v30, v30, v110, v111
    v_max3_u32 v30, v30, v112, v113
    v_max3_u32 v30, v30, v114, v115
    v_max3_u32 v30, v30, v116, v117
    v_max3_u32 v30, v30, v118, v119
    v_max3_u32 v30, v30, v120, v121
    v_max3_u32 v30, v30, v122, v123
    v_max3_u32 v30, v30, v124, v125
    v_max3_u32 v30, v30, v126, v127
    v_max3_u32 v30, v30, v128, v129
    v_max3_u32 v30, v30, v130, v131
    v_cmp_eq_u32 vcc, -1, v30
    s_cmp_gt_u32 s9, 131072
    s_cbranch_scc1 L1_pd
    s_cbranch_vccz L1_pd
    s_mov_b64 exec, vcc
    s_sleep 4
    s_branch L1_p
L1_pd:
    s_mov_b64 exec, -1
    v_mov_b32 v64, v60
    v_mov_b32 v65, v61
    v_mov_b32 v66, v62
    v_mov_b32 v67, v63
    s_nop 1
    v_permlane32_swap_b32 v60, v64
    v_permlane32_swap_b32 v61, v65
    v_permlane32_swap_b32 v62, v66
    v_permlane32_swap_b32 v63, v67
    s_nop 1
    v_add_f32 v60, v60, v64
    v_add_f32 v61, v61, v65
    v_add_f32 v62, v62, v66
    v_add_f32 v63, v63, v67
    v_mov_b32 v64, v60
    v_mov_b32 v65, v61
    v_mov_b32 v66, v62
    v_mov_b32 v67, v63
    s_nop 1
    v_permlane16_swap_b32 v60, v64
    v_permlane16_swap_b32 v61, v65
    v_permlane16_swap_b32 v62, v66
    v_permlane16_swap_b32 v63, v67
    s_nop 1
    v_add_f32 v60, v60, v64
    v_add_f32 v61, v61, v65
    v_add_f32 v62, v62, v66
    v_add_f32 v63, v63, v67
    v_cvt_pk_bf16_f32 v60, v60, v61
    v_cvt_pk_bf16_f32 v61, v62, v63
    v_min_u32 v60, -2, v60
    v_min_u32 v61, -2, v61
    s_mov_b32 exec_lo, 0x3fff
    s_mov_b32 exec_hi, 0
    buffer_store_dwordx2 v[60:61], v49, s[40:43], s61 offen sc1
    s_mov_b64 exec, -1
    v_mov_b32 v112, 0
    v_mov_b32 v113, 0
    v_mov_b32 v114, 0
    v_mov_b32 v115, 0
    v_add_u32 v50, 112640, v18
    s_barrier
    s_waitcnt vmcnt(0)
    s_mov_b32 s9, 0
L1_g:
    s_mov_b64 s[70:71], exec
    buffer_load_dwordx4 v[100:103], v18, s[40:43], s60 offen offset:0 sc1
    buffer_load_dwordx4 v[104:107], v18, s[40:43], s60 offen offset:1024 sc1
    buffer_load_dwordx4 v[108:111], v18, s[40:43], s60 offen offset:2048 sc1
    s_and_b32 exec_lo, exec_lo, 0x3ffff
    s_mov_b32 exec_hi, 0
    buffer_load_dwordx4 v[112:115], v18, s[40:43], s60 offen offset:3072 sc1
    s_mov_b64 exec, s[70:71]
    s_add_u32 s9, s9, 1
    s_waitcnt vmcnt(0)
    v_max_u32 v30, v100, v101
    v_max3_u32 v30, v30, v102, v103
    v_max3_u32 v30, v30, v104, v105
    v_max3_u32 v30, v30, v106, v107
    v_max3_u32 v30, v30, v108, v109
    v_max3_u32 v30, v30, v110, v111
    v_max3_u32 v30, v30, v112, v113
    v_max3_u32 v30, v30, v114, v115
    v_cmp_eq_u32 vcc, -1, v30
    s_cmp_gt_u32 s9, 131072
    s_cbranch_scc1 L1_gd
    s_cbranch_vccz L1_gd
    s_mov_b64 exec, vcc
    s_sleep 4
    s_branch L1_g
L1_gd:
    s_mov_b64 exec, -1
    ds_write_b128 v50, v[100:103] offset:0
    ds_write_b128 v50, v[104:107] offset:1024
    ds_write_b128 v50, v[108:111] offset:2048
    ds_write_b128 v50, v[112:115] offset:3072
    s_waitcnt lgkmcnt(0)
    s_barrier
    s_mov_b32 s12, 0
    s_barrier
    s_barrier
    s_lshl_b32 s70, s4, 7
    s_lshl_b32 s8, s5, 2
    s_add_u32 s70, s70, s8
    s_add_u32 s71, s70, 7536640
    s_add_u32 s70, s70, 7569408
    s_barrier
    s_call_b64 s[62:63], L_issueWo
    s_barrier
    s_call_b64 s[62:63], L_issueWo
    s_waitcnt vmcnt(38)
    s_barrier
    s_call_b64 s[62:63], L_issueWo
    s_waitcnt vmcnt(38)
    s_barrier
    s_call_b64 s[62:63], L_issueWo
    s_add_u32 s69, s69, 3
    s_and_b32 s69, s69, 3
    s_mov_b32 s61, 0
    s_waitcnt vmcnt(40)
    s_barrier
    s_call_b64 s[62:63], L_issueP
    v_mov_b32 v30, s96
    v_mov_b32 v31, 0
    s_mov_b64 exec, 1
    buffer_store_dword v30, v31, s[40:43], s70 offen sc1
    s_mov_b64 exec, -1
    v_mov_b32 v30, s96
    v_mov_b32 v31, 0
    s_mov_b64 exec, 1
    buffer_store_dword v30, v31, s[40:43], s71 offen sc1
    s_mov_b64 exec, -1
    s_waitcnt vmcnt(47)
    s_barrier
    s_waitcnt vmcnt(22)
    s_barrier
    s_waitcnt vmcnt(2)
    s_barrier
L_end:
    s_endpgm
L_issueA:
    s_lshl_b32 s15, s10, 10
    s_add_u32 m0, s15, s12
    s_lshl_b32 s14, s11, 7
    s_add_u32 s14, s14, s13
    buffer_load_dwordx4 v2, s[44:47], s14 offen  lds
    s_add_u32 m0, m0, 2048
    s_add_u32 s14, s14, 20480
    buffer_load_dwordx4 v2, s[44:47], s14 offen  lds
    s_add_u32 m0, m0, 2048
    s_add_u32 s14, s14, 20480
    buffer_load_dwordx4 v2, s[44:47], s14 offen  lds
    s_add_u32 m0, m0, 2048
    s_add_u32 s14, s14, 20480
    buffer_load_dwordx4 v2, s[44:47], s14 offen  lds
    s_mul_i32 s15, s10, 5120
    s_add_u32 s15, s15, s12
    s_add_u32 m0, s15, 8192
    s_mul_i32 s14, s11, 81920
    s_add_u32 s14, s14, s65
    buffer_load_dwordx4 v3, s[48:51], s14 offen  lds
    s_add_u32 m0, m0, 1024
    s_nop 0
    buffer_load_dwordx4 v4, s[48:51], s14 offen  lds
    s_add_u32 m0, m0, 1024
    s_nop 0
    buffer_load_dwordx4 v5, s[48:51], s14 offen  lds
    s_add_u32 m0, m0, 1024
    s_nop 0
    buffer_load_dwordx4 v6, s[48:51], s14 offen  lds
    s_add_u32 m0, m0, 1024
    s_nop 0
    buffer_load_dwordx4 v7, s[48:51], s14 offen  lds
    s_add_u32 s11, s11, 1
    s_cmp_eq_u32 s11, 10
    s_cselect_b32 s11, 0, s11
    s_add_u32 s12, s12, 19456
    s_cmp_eq_u32 s12, 116736
    s_cselect_b32 s12, 0, s12
    s_setpc_b64 s[62:63]
L_issueB1:
    s_lshl_b32 s15, s10, 10
    s_add_u32 m0, s15, s12
    s_lshl_b32 s14, s11, 7
    s_add_u32 s14, s14, s13
    buffer_load_dwordx4 v2, s[72:75], s14 offen  lds
    s_add_u32 m0, m0, 2048
    s_add_u32 s14, s14, 20480
    buffer_load_dwordx4 v2, s[72:75], s14 offen  lds
    s_add_u32 m0, m0, 2048
    s_add_u32 s14, s14, 20480
    buffer_load_dwordx4 v2, s[72:75], s14 offen  lds
    s_add_u32 m0, m0, 2048
    s_add_u32 s14, s14, 20480
    buffer_load_dwordx4 v2, s[72:75], s14 offen  lds
    s_mul_i32 s15, s10, 5120
    s_add_u32 s15, s15, s12
    s_add_u32 m0, s15, 8192
    s_mul_i32 s14, s11, 245760
    s_add_u32 s14, s14, s66
    buffer_load_dwordx4 v8, s[76:79], s14 offen  lds
    s_add_u32 m0, m0, 1024
    s_nop 0
    buffer_load_dwordx4 v9, s[76:79], s14 offen  lds
    s_add_u32 m0, m0, 1024
    s_nop 0
    buffer_load_dwordx4 v10, s[76:79], s14 offen  lds
    s_add_u32 m0, m0, 1024
    s_nop 0
    buffer_load_dwordx4 v11, s[76:79], s14 offen  lds
    s_add_u32 m0, m0, 1024
    s_nop 0
    buffer_load_dwordx4 v12, s[76:79], s14 offen  lds
    s_setpc_b64 s[62:63]
L_issueB:
    s_lshl_b32 s15, s10, 10
    s_add_u32 m0, s15, s12
    s_lshl_b32 s14, s11, 7
    s_add_u32 s14, s14, s13
    buffer_load_dwordx4 v2, s[72:75], s14 offen  lds
    s_add_u32 m0, m0, 2048
    s_add_u32 s14, s14, 20480
    buffer_load_dwordx4 v2, s[72:75], s14 offen  lds
    s_add_u32 m0, m0, 2048
    s_add_u32 s14, s14, 20480
    buffer_load_dwordx4 v2, s[72:75], s14 offen  lds
    s_add_u32 m0, m0, 2048
    s_add_u32 s14, s14, 20480
    buffer_load_dwordx4 v2, s[72:75], s14 offen  lds
    s_mul_i32 s15, s10, 5120
    s_add_u32 s15, s15, s12
    s_add_u32 m0, s15, 8192
    s_mul_i32 s14, s11, 245760
    s_add_u32 s14, s14, s66
    buffer_load_dwordx4 v8, s[76:79], s14 offen  lds
    s_add_u32 m0, m0, 1024
    s_nop 0
    buffer_load_dwordx4 v9, s[76:79], s14 offen  lds
    s_add_u32 m0, m0, 1024
    s_nop 0
    buffer_load_dwordx4 v10, s[76:79], s14 offen  lds
    s_add_u32 m0, m0, 1024
    s_nop 0
    buffer_load_dwordx4 v11, s[76:79], s14 offen  lds
    s_add_u32 m0, m0, 1024
    s_nop 0
    buffer_load_dwordx4 v12, s[76:79], s14 offen  lds
L_issueB2:
    s_mul_i32 s15, s10, 10240
    s_add_u32 s15, s15, s12
    s_add_u32 m0, s15, 18432
    s_mul_i32 s14, s11, 245760
    s_add_u32 s14, s14, s67
    buffer_load_dwordx4 v13, s[76:79], s14 offen  lds
    s_add_u32 m0, m0, 1024
    s_nop 0
    buffer_load_dwordx4 v14, s[76:79], s14 offen  lds
    s_add_u32 m0, m0, 1024
    s_nop 0
    buffer_load_dwordx4 v15, s[76:79], s14 offen  lds
    s_add_u32 m0, m0, 1024
    s_nop 0
    buffer_load_dwordx4 v16, s[76:79], s14 offen  lds
    s_add_u32 m0, m0, 1024
    s_nop 0
    buffer_load_dwordx4 v17, s[76:79], s14 offen  lds
    s_add_u32 m0, m0, 1024
    s_add_u32 s14, s14, 61440
    buffer_load_dwordx4 v13, s[76:79], s14 offen  lds
    s_add_u32 m0, m0, 1024
    s_nop 0
    buffer_load_dwordx4 v14, s[76:79], s14 offen  lds
    s_add_u32 m0, m0, 1024
    s_nop 0
    buffer_load_dwordx4 v15, s[76:79], s14 offen  lds
    s_add_u32 m0, m0, 1024
    s_nop 0
    buffer_load_dwordx4 v16, s[76:79], s14 offen  lds
    s_add_u32 m0, m0, 1024
    s_nop 0
    buffer_load_dwordx4 v17, s[76:79], s14 offen  lds
    s_add_u32 s11, s11, 1
    s_cmp_eq_u32 s11, 10
    s_cselect_b32 s11, 0, s11
    s_add_u32 s12, s12, 38912
    s_cmp_eq_u32 s12, 116736
    s_cselect_b32 s12, 0, s12
    s_setpc_b64 s[62:63]
L_issueKV:
    s_mov_b32 m0, s61
    s_mul_i32 s14, s60, 11264
    s_add_u32 s14, s14, 5242880
    buffer_load_dwordx4 v18, s[40:43], s14 offen offset:0 sc1 lds
    buffer_load_dwordx4 v18, s[40:43], s14 offen offset:1024 sc1 lds
    buffer_load_dwordx4 v18, s[40:43], s14 offen offset:2048 sc1 lds
    buffer_load_dwordx4 v18, s[40:43], s14 offen offset:3072 sc1 lds
    s_add_u32 m0, m0, 4096
    s_add_u32 s14, s14, 4096
    buffer_load_dwordx4 v18, s[40:43], s14 offen offset:0 sc1 lds
    buffer_load_dwordx4 v18, s[40:43], s14 offen offset:1024 sc1 lds
    buffer_load_dwordx4 v18, s[40:43], s14 offen offset:2048 sc1 lds
    buffer_load_dwordx4 v18, s[40:43], s14 offen offset:3072 sc1 lds
    s_add_u32 m0, m0, 4096
    s_add_u32 s14, s14, 4096
    buffer_load_dwordx4 v18, s[40:43], s14 offen offset:0 sc1 lds
    buffer_load_dwordx4 v18, s[40:43], s14 offen offset:1024 sc1 lds
    buffer_load_dwordx4 v18, s[40:43], s14 offen offset:2048 sc1 lds
    s_add_u32 s60, s60, 1
    s_and_b32 s60, s60, 15
    s_add_u32 s61, s61, 11264
    s_cmp_eq_u32 s61, 161792
    s_cselect_b32 s61, 116736, s61
    s_setpc_b64 s[62:63]
L_issuePa:
    s_mov_b32 m0, s61
    s_mul_i32 s14, s69, 20480
    s_add_u32 s14, s14, s13
    buffer_load_dwordx4 v18, s[40:43], s14 offen offset:0 sc1 lds
    buffer_load_dwordx4 v18, s[40:43], s14 offen offset:1024 sc1 lds
    buffer_load_dwordx4 v18, s[40:43], s14 offen offset:2048 sc1 lds
    buffer_load_dwordx4 v18, s[40:43], s14 offen offset:3072 sc1 lds
    s_add_u32 m0, m0, 4096
    s_add_u32 s14, s14, 4096
    buffer_load_dwordx4 v18, s[40:43], s14 offen offset:0 sc1 lds
    buffer_load_dwordx4 v18, s[40:43], s14 offen offset:1024 sc1 lds
    buffer_load_dwordx4 v18, s[40:43], s14 offen offset:2048 sc1 lds
    buffer_load_dwordx4 v18, s[40:43], s14 offen offset:3072 sc1 lds
    s_add_u32 m0, m0, 4096
    s_add_u32 s14, s14, 4096
    buffer_load_dwordx4 v18, s[40:43], s14 offen offset:0 sc1 lds
    buffer_load_dwordx4 v18, s[40:43], s14 offen offset:1024 sc1 lds
    s_setpc_b64 s[62:63]
L_issuePb:
    s_add_u32 m0, s61, 10240
    s_mul_i32 s14, s69, 20480
    s_add_u32 s14, s14, s13
    s_add_u32 s14, s14, 10240
    buffer_load_dwordx4 v18, s[40:43], s14 offen offset:0 sc1 lds
    buffer_load_dwordx4 v18, s[40:43], s14 offen offset:1024 sc1 lds
    buffer_load_dwordx4 v18, s[40:43], s14 offen offset:2048 sc1 lds
    buffer_load_dwordx4 v18, s[40:43], s14 offen offset:3072 sc1 lds
    s_add_u32 m0, m0, 4096
    s_add_u32 s14, s14, 4096
    buffer_load_dwordx4 v18, s[40:43], s14 offen offset:0 sc1 lds
    buffer_load_dwordx4 v18, s[40:43], s14 offen offset:1024 sc1 lds
    buffer_load_dwordx4 v18, s[40:43], s14 offen offset:2048 sc1 lds
    buffer_load_dwordx4 v18, s[40:43], s14 offen offset:3072 sc1 lds
    s_add_u32 m0, m0, 4096
    s_add_u32 s14, s14, 4096
    buffer_load_dwordx4 v18, s[40:43], s14 offen offset:0 sc1 lds
    buffer_load_dwordx4 v18, s[40:43], s14 offen offset:1024 sc1 lds
    s_branch L_issuePe
L_issueP:
    s_mov_b32 m0, s61
    s_mul_i32 s14, s69, 20480
    s_add_u32 s14, s14, s13
    buffer_load_dwordx4 v18, s[40:43], s14 offen offset:0 sc1 lds
    buffer_load_dwordx4 v18, s[40:43], s14 offen offset:1024 sc1 lds
    buffer_load_dwordx4 v18, s[40:43], s14 offen offset:2048 sc1 lds
    buffer_load_dwordx4 v18, s[40:43], s14 offen offset:3072 sc1 lds
    s_add_u32 m0, m0, 4096
    s_add_u32 s14, s14, 4096
    buffer_load_dwordx4 v18, s[40:43], s14 offen offset:0 sc1 lds
    buffer_load_dwordx4 v18, s[40:43], s14 offen offset:1024 sc1 lds
    buffer_load_dwordx4 v18, s[40:43], s14 offen offset:2048 sc1 lds
    buffer_load_dwordx4 v18, s[40:43], s14 offen offset:3072 sc1 lds
    s_add_u32 m0, m0, 4096
    s_add_u32 s14, s14, 4096
    buffer_load_dwordx4 v18, s[40:43], s14 offen offset:0 sc1 lds
    buffer_load_dwordx4 v18, s[40:43], s14 offen offset:1024 sc1 lds
    buffer_load_dwordx4 v18, s[40:43], s14 offen offset:2048 sc1 lds
    buffer_load_dwordx4 v18, s[40:43], s14 offen offset:3072 sc1 lds
    s_add_u32 m0, m0, 4096
    s_add_u32 s14, s14, 4096
    buffer_load_dwordx4 v18, s[40:43], s14 offen offset:0 sc1 lds
    buffer_load_dwordx4 v18, s[40:43], s14 offen offset:1024 sc1 lds
    buffer_load_dwordx4 v18, s[40:43], s14 offen offset:2048 sc1 lds
    buffer_load_dwordx4 v18, s[40:43], s14 offen offset:3072 sc1 lds
    s_add_u32 m0, m0, 4096
    s_add_u32 s14, s14, 4096
    buffer_load_dwordx4 v18, s[40:43], s14 offen offset:0 sc1 lds
    buffer_load_dwordx4 v18, s[40:43], s14 offen offset:1024 sc1 lds
    buffer_load_dwordx4 v18, s[40:43], s14 offen offset:2048 sc1 lds
    buffer_load_dwordx4 v18, s[40:43], s14 offen offset:3072 sc1 lds
L_issuePe:
    s_add_u32 s69, s69, 1
    s_and_b32 s69, s69, 3
    s_add_u32 s61, s61, 20480
    s_cmp_eq_u32 s61, 163840
    s_cselect_b32 s61, 102400, s61
    s_setpc_b64 s[62:63]
L_issueWo:
    s_mov_b32 m0, s12
    s_mul_i32 s14, s69, 25600
    s_add_u32 s14, s14, s64
    buffer_load_dwordx4 v18, s[40:43], s14 offen offset:0 sc1 lds
    buffer_load_dwordx4 v18, s[40:43], s14 offen offset:1024 sc1 lds
    buffer_load_dwordx4 v18, s[40:43], s14 offen offset:2048 sc1 lds
    buffer_load_dwordx4 v18, s[40:43], s14 offen offset:3072 sc1 lds
    s_add_u32 m0, m0, 4096
    s_add_u32 s14, s14, 4096
    buffer_load_dwordx4 v18, s[40:43], s14 offen offset:0 sc1 lds
    buffer_load_dwordx4 v18, s[40:43], s14 offen offset:1024 sc1 lds
    buffer_load_dwordx4 v18, s[40:43], s14 offen offset:2048 sc1 lds
    buffer_load_dwordx4 v18, s[40:43], s14 offen offset:3072 sc1 lds
    s_add_u32 m0, m0, 4096
    s_add_u32 s14, s14, 4096
    buffer_load_dwordx4 v18, s[40:43], s14 offen offset:0 sc1 lds
    buffer_load_dwordx4 v18, s[40:43], s14 offen offset:1024 sc1 lds
    buffer_load_dwordx4 v18, s[40:43], s14 offen offset:2048 sc1 lds
    buffer_load_dwordx4 v18, s[40:43], s14 offen offset:3072 sc1 lds
    s_add_u32 m0, m0, 4096
    s_add_u32 s14, s14, 4096
    buffer_load_dwordx4 v18, s[40:43], s14 offen offset:0 sc1 lds
    buffer_load_dwordx4 v18, s[40:43], s14 offen offset:1024 sc1 lds
    buffer_load_dwordx4 v18, s[40:43], s14 offen offset:2048 sc1 lds
    buffer_load_dwordx4 v18, s[40:43], s14 offen offset:3072 sc1 lds
    s_add_u32 m0, m0, 4096
    s_add_u32 s14, s14, 4096
    buffer_load_dwordx4 v18, s[40:43], s14 offen offset:0 sc1 lds
    buffer_load_dwordx4 v18, s[40:43], s14 offen offset:1024 sc1 lds
    buffer_load_dwordx4 v18, s[40:43], s14 offen offset:2048 sc1 lds
    buffer_load_dwordx4 v18, s[40:43], s14 offen offset:3072 sc1 lds
    s_add_u32 m0, m0, 4096
    s_add_u32 s14, s14, 4096
    buffer_load_dwordx4 v18, s[40:43], s14 offen offset:0 sc1 lds
    buffer_load_dwordx4 v18, s[40:43], s14 offen offset:1024 sc1 lds
    buffer_load_dwordx4 v18, s[40:43], s14 offen offset:2048 sc1 lds
    buffer_load_dwordx4 v18, s[40:43], s14 offen offset:3072 sc1 lds
    s_add_u32 m0, m0, 4096
    s_add_u32 s14, s14, 4096
    buffer_load_dwordx4 v18, s[40:43], s14 offen offset:0 sc1 lds
    s_add_u32 s69, s69, 1
    s_and_b32 s69, s69, 3
    s_add_u32 s12, s12, 25600
    s_setpc_b64 s[62:63]
L_codeend:
.section .rodata,"a"
.p2align 6
.amdhsa_kernel concat_heads__grouped_kv_mqa__linear_attn_block__prompt_kernel
  .amdhsa_next_free_vgpr 168
  .amdhsa_next_free_sgpr 102
  .amdhsa_accum_offset 168
  .amdhsa_group_segment_fixed_size 0
  .amdhsa_kernarg_size 88
  .amdhsa_user_sgpr_count 2
  .amdhsa_user_sgpr_kernarg_segment_ptr 1
  .amdhsa_system_sgpr_workgroup_id_x 1
.end_amdhsa_kernel
```
